```python
import torch

def _softmax(x, axis=-1):
    return torch.softmax(x, dim=axis)
def _gelu(x):
    return torch.nn.functional.gelu(x, approximate="tanh")
def _silu(x):
    return torch.nn.functional.silu(x)
def _sigmoid(x):
    return torch.sigmoid(x)
def _layernorm(x, axis=-1, eps=1e-5):
    m = x.mean(dim=axis, keepdim=True)
    v = x.var(dim=axis, keepdim=True, unbiased=False)
    return (x - m) / torch.sqrt(v + eps)
def _scatter_add(tgt, idx, src, axis=0):
    return tgt.clone().index_add_(axis, idx, src)
def _segment_sum(src, seg, n):
    out = torch.zeros((n,) + src.shape[1:], dtype=src.dtype)
    return out.index_add_(0, seg, src)
def _pad(x, pw):
    flat = tuple(v for pair in reversed(pw) for v in pair)
    return torch.nn.functional.pad(x, flat)

kernel_name = 'gated_mix__gqa_block_cached__geglu_ffn__decode'

def setup_inputs():

    _w = (lambda a: (lambda t: t.to(torch.bfloat16) if t.is_floating_point() else t)(torch.as_tensor(a)))
    def _A_setup():
        B, Sq, D = 2, 1, 576
        Hq, Hkv, Sk, Dh = 32, 16, 32768, 128
        assert Hq % Hkv == 0, (Hq, Hkv)
        return {
            "x": _w((lambda *s: torch.randn(*s, dtype=torch.bfloat16) * 0.05)(B, Sq, D)),
            "k_cache": _w((lambda *s: torch.randn(*s, dtype=torch.bfloat16) * 6.4)(B, Hkv, Sk, Dh)),
            "v_cache": _w((lambda *s: torch.randn(*s, dtype=torch.bfloat16) * 0.4)(B, Hkv, Sk, Dh)),
            "wq": _w((lambda *s: torch.randn(*s, dtype=torch.bfloat16) * 6.4)(D, Hq * Dh) * (D ** -0.5)),
            "wo": _w((lambda *s: torch.randn(*s, dtype=torch.bfloat16) * 0.4)(Hq * Dh, D) * ((Hq * Dh) ** -0.5)),
        }
    _A_in = _A_setup()

    def _B_setup():
        B, S, D, F = 2, 1, 576, 4608
        return {
            "x": _w((lambda *s: torch.randn(*s, dtype=torch.bfloat16) * 0.05)(B, S, D)),
            "w_gate": _w((lambda *s: torch.randn(*s, dtype=torch.bfloat16) * 0.05)(D, F)),
            "w_up": _w((lambda *s: torch.randn(*s, dtype=torch.bfloat16) * 0.05)(D, F)),
            "w_down": _w((lambda *s: torch.randn(*s, dtype=torch.bfloat16) * 0.05)(F, D)),
        }
    _B_in = _B_setup()

    return {
        "A_x": _A_in["x"],
        "A_k_cache": _A_in["k_cache"],
        "A_v_cache": _A_in["v_cache"],
        "A_wq": _A_in["wq"],
        "A_wo": _A_in["wo"],
        "B_x": _B_in["x"],
        "B_w_gate": _B_in["w_gate"],
        "B_w_up": _B_in["w_up"],
        "B_w_down": _B_in["w_down"],
        "gate_w": _w((lambda *s: torch.randn(*s, dtype=torch.bfloat16) * 0.05)(576) * 16.0),
    }

def reference(A_x, A_k_cache, A_v_cache, A_wq, A_wo, B_x, B_w_gate, B_w_up, B_w_down, gate_w):
    def _A_ref(x, k_cache, v_cache, wq, wo):
        B, Sq, D = x.shape
        Hq, Dh = 32, 128
        Hkv = k_cache.shape[1]
        rep = Hq // Hkv
        q = (lambda x, *d: x.permute(*d))((x @ wq).reshape(B, Sq, Hq, Dh), 0, 2, 1, 3)
        k = (lambda x, n, axis: torch.repeat_interleave(x, n, dim=axis))(k_cache, rep, axis=1)
        v = (lambda x, n, axis: torch.repeat_interleave(x, n, dim=axis))(v_cache, rep, axis=1)
        scores = torch.einsum("bhqd,bhkd->bhqk", q, k) * (Dh ** -0.5)
        p = _softmax(scores, axis=-1)
        o = torch.einsum("bhqk,bhkd->bhqd", p, v)
        return (lambda x, *d: x.permute(*d))(o, 0, 2, 1, 3).reshape(B, Sq, Hq * Dh) @ wo

    def _B_ref(x, w_gate, w_up, w_down):
        return (_gelu(x @ w_gate) * (x @ w_up)) @ w_down

    x = A_x
    g = _sigmoid((x * gate_w).sum(-1, keepdims=True))
    a = _A_ref(x, A_k_cache, A_v_cache, A_wq, A_wo)
    b = _B_ref(x, B_w_gate, B_w_up, B_w_down)
    return g * a + (1 - g) * b
```

```asm
; @launch grid=(256,1,1) block=(512,1,1) lds=121984
.amdgcn_target "amdgcn-amd-amdhsa--gfx950"
.text
.globl gated_mix__gqa_block_cached__geglu_ffn__decode_kernel
.p2align 8
.type gated_mix__gqa_block_cached__geglu_ffn__decode_kernel,@function
gated_mix__gqa_block_cached__geglu_ffn__decode_kernel:
    s_cmp_ge_u32 s2, 256
    s_cbranch_scc1 L_end
    s_load_dwordx16 s[8:23], s[0:1], 0
    s_load_dwordx8 s[24:31], s[0:1], 64
    s_load_dwordx2 s[32:33], s[0:1], 96
    v_lshrrev_b32 v4, 6, v0
    v_and_b32 v1, 63, v0
    v_readfirstlane_b32 s34, v4
    v_lshrrev_b32 v2, 4, v1
    v_and_b32 v3, 15, v1
    s_and_b32 s3, s2, 7
    s_lshr_b32 s4, s2, 3
    s_lshl_b32 s3, s3, 1
    s_and_b32 s5, s4, 1
    s_add_u32 s35, s3, s5
    s_lshr_b32 s5, s4, 1
    s_and_b32 s36, s5, 1
    s_lshr_b32 s37, s4, 2
    s_and_b32 s38, s34, 3
    s_cmp_ge_u32 s34, 4
    s_cbranch_scc1 L_helper
    v_add_u32 v24, 0, v2
    v_xor_b32 v24, v24, v3
    v_lshlrev_b32 v24, 4, v24
    v_lshl_add_u32 v4, v2, 8, v24
    v_add_u32 v24, 4, v2
    v_xor_b32 v24, v24, v3
    v_lshlrev_b32 v24, 4, v24
    v_lshl_add_u32 v5, v2, 8, v24
    v_add_u32 v24, 8, v2
    v_xor_b32 v24, v24, v3
    v_lshlrev_b32 v24, 4, v24
    v_lshl_add_u32 v6, v2, 8, v24
    v_add_u32 v24, 12, v2
    v_xor_b32 v24, v24, v3
    v_lshlrev_b32 v24, 4, v24
    v_lshl_add_u32 v7, v2, 8, v24
    v_lshlrev_b32 v24, 4, v3
    v_lshl_add_u32 v8, v2, 10, v24
    s_mul_i32 s50, s38, 24576
    v_add_u32 v24, 0, v2
    v_xor_b32 v24, v24, v3
    v_lshlrev_b32 v24, 4, v24
    v_lshl_add_u32 v24, v3, 8, v24
    v_add_u32 v9, s50, v24
    v_add_u32 v24, 4, v2
    v_xor_b32 v24, v24, v3
    v_lshlrev_b32 v24, 4, v24
    v_lshl_add_u32 v24, v3, 8, v24
    v_add_u32 v10, s50, v24
    v_add_u32 v24, 8, v2
    v_xor_b32 v24, v24, v3
    v_lshlrev_b32 v24, 4, v24
    v_lshl_add_u32 v24, v3, 8, v24
    v_add_u32 v11, s50, v24
    v_add_u32 v24, 12, v2
    v_xor_b32 v24, v24, v3
    v_lshlrev_b32 v24, 4, v24
    v_lshl_add_u32 v24, v3, 8, v24
    v_add_u32 v12, s50, v24
    s_lshl_b32 s3, s36, 4
    s_add_u32 s3, s3, s35
    s_lshl_b32 s3, s3, 3
    s_add_u32 s3, s3, s37
    s_lshl_b32 s3, s3, 20
    s_lshl_b32 s48, s38, 12
    s_waitcnt lgkmcnt(0)
    s_add_u32 s40, s10, s3
    s_addc_u32 s41, s11, 0
    s_and_b32 s41, s41, 0xffff
    s_mov_b32 s42, 1048576
    s_mov_b32 s43, 0x00020000
    s_add_u32 s44, s12, s3
    s_addc_u32 s45, s13, 0
    s_and_b32 s45, s45, 0xffff
    s_mov_b32 s46, 1048576
    s_mov_b32 s47, 0x00020000
    s_waitcnt vmcnt(5)
    s_add_u32 m0, s50, 0
    s_nop 0
    buffer_load_dwordx4 v4, s[40:43], s48 offen offset:0 nt lds
    s_waitcnt vmcnt(5)
    buffer_load_dwordx4 v5, s[40:43], s48 offen offset:1024 nt lds
    s_waitcnt vmcnt(5)
    buffer_load_dwordx4 v6, s[40:43], s48 offen offset:2048 nt lds
    s_waitcnt vmcnt(5)
    buffer_load_dwordx4 v7, s[40:43], s48 offen offset:3072 nt lds
    s_waitcnt vmcnt(5)
    buffer_load_dwordx4 v[88:91], v8, s[44:47], s48 offen offset:0 nt
    s_waitcnt vmcnt(5)
    buffer_load_dwordx4 v[92:95], v8, s[44:47], s48 offen offset:256 nt
    s_waitcnt vmcnt(5)
    buffer_load_dwordx4 v[96:99], v8, s[44:47], s48 offen offset:512 nt
    s_waitcnt vmcnt(5)
    buffer_load_dwordx4 v[100:103], v8, s[44:47], s48 offen offset:768 nt
    s_add_u32 s48, s48, 16384
    s_waitcnt vmcnt(5)
    s_add_u32 m0, s50, 4096
    s_nop 0
    buffer_load_dwordx4 v4, s[40:43], s48 offen offset:0 nt lds
    s_waitcnt vmcnt(5)
    buffer_load_dwordx4 v5, s[40:43], s48 offen offset:1024 nt lds
    s_waitcnt vmcnt(5)
    buffer_load_dwordx4 v6, s[40:43], s48 offen offset:2048 nt lds
    s_waitcnt vmcnt(5)
    buffer_load_dwordx4 v7, s[40:43], s48 offen offset:3072 nt lds
    s_waitcnt vmcnt(5)
    buffer_load_dwordx4 v[104:107], v8, s[44:47], s48 offen offset:0 nt
    s_waitcnt vmcnt(5)
    buffer_load_dwordx4 v[108:111], v8, s[44:47], s48 offen offset:256 nt
    s_waitcnt vmcnt(5)
    buffer_load_dwordx4 v[112:115], v8, s[44:47], s48 offen offset:512 nt
    s_waitcnt vmcnt(5)
    buffer_load_dwordx4 v[116:119], v8, s[44:47], s48 offen offset:768 nt
    s_add_u32 s48, s48, 16384
    s_waitcnt vmcnt(5)
    s_add_u32 m0, s50, 8192
    s_nop 0
    buffer_load_dwordx4 v4, s[40:43], s48 offen offset:0 nt lds
    s_waitcnt vmcnt(5)
    buffer_load_dwordx4 v5, s[40:43], s48 offen offset:1024 nt lds
    s_waitcnt vmcnt(5)
    buffer_load_dwordx4 v6, s[40:43], s48 offen offset:2048 nt lds
    s_waitcnt vmcnt(5)
    buffer_load_dwordx4 v7, s[40:43], s48 offen offset:3072 nt lds
    s_waitcnt vmcnt(5)
    buffer_load_dwordx4 v[120:123], v8, s[44:47], s48 offen offset:0 nt
    s_waitcnt vmcnt(5)
    buffer_load_dwordx4 v[124:127], v8, s[44:47], s48 offen offset:256 nt
    s_waitcnt vmcnt(5)
    buffer_load_dwordx4 v[128:131], v8, s[44:47], s48 offen offset:512 nt
    s_waitcnt vmcnt(5)
    buffer_load_dwordx4 v[132:135], v8, s[44:47], s48 offen offset:768 nt
    s_add_u32 s48, s48, 16384
    s_waitcnt vmcnt(5)
    s_add_u32 m0, s50, 12288
    s_nop 0
    buffer_load_dwordx4 v4, s[40:43], s48 offen offset:0 nt lds
    s_waitcnt vmcnt(5)
    buffer_load_dwordx4 v5, s[40:43], s48 offen offset:1024 nt lds
    s_waitcnt vmcnt(5)
    buffer_load_dwordx4 v6, s[40:43], s48 offen offset:2048 nt lds
    s_waitcnt vmcnt(5)
    buffer_load_dwordx4 v7, s[40:43], s48 offen offset:3072 nt lds
    s_waitcnt vmcnt(5)
    buffer_load_dwordx4 v[136:139], v8, s[44:47], s48 offen offset:0 nt
    s_waitcnt vmcnt(5)
    buffer_load_dwordx4 v[140:143], v8, s[44:47], s48 offen offset:256 nt
    s_waitcnt vmcnt(5)
    buffer_load_dwordx4 v[144:147], v8, s[44:47], s48 offen offset:512 nt
    s_waitcnt vmcnt(5)
    buffer_load_dwordx4 v[148:151], v8, s[44:47], s48 offen offset:768 nt
    s_add_u32 s48, s48, 16384
    s_waitcnt vmcnt(5)
    s_add_u32 m0, s50, 16384
    s_nop 0
    buffer_load_dwordx4 v4, s[40:43], s48 offen offset:0 nt lds
    s_waitcnt vmcnt(5)
    buffer_load_dwordx4 v5, s[40:43], s48 offen offset:1024 nt lds
    s_waitcnt vmcnt(5)
    buffer_load_dwordx4 v6, s[40:43], s48 offen offset:2048 nt lds
    s_waitcnt vmcnt(5)
    buffer_load_dwordx4 v7, s[40:43], s48 offen offset:3072 nt lds
    s_waitcnt vmcnt(5)
    buffer_load_dwordx4 v[152:155], v8, s[44:47], s48 offen offset:0 nt
    s_waitcnt vmcnt(5)
    buffer_load_dwordx4 v[156:159], v8, s[44:47], s48 offen offset:256 nt
    s_waitcnt vmcnt(5)
    buffer_load_dwordx4 v[160:163], v8, s[44:47], s48 offen offset:512 nt
    s_waitcnt vmcnt(5)
    buffer_load_dwordx4 v[164:167], v8, s[44:47], s48 offen offset:768 nt
    s_add_u32 s48, s48, 16384
    v_and_b32 v24, 1, v1
    v_cmp_eq_u32 vcc, 1, v24
    v_mov_b32 v24, 0x0c0c0100
    v_mov_b32 v25, 0x01000c0c
    s_nop 1
    v_cndmask_b32 v24, v24, v25, vcc
    v_mov_b32 v25, 0x0c0c0302
    v_mov_b32 v17, 0x03020c0c
    v_cndmask_b32 v25, v25, v17, vcc
    v_bfe_u32 v20, v1, 1, 2
    v_mov_b32 v16, 0x0c0c0c0c
    v_cmp_eq_u32 vcc, 0, v20
    s_nop 1
    v_cndmask_b32 v13, v16, v24, vcc
    v_cndmask_b32 v17, v16, v25, vcc
    v_cmp_eq_u32 vcc, 1, v20
    s_nop 1
    v_cndmask_b32 v14, v16, v24, vcc
    v_cndmask_b32 v18, v16, v25, vcc
    v_cmp_eq_u32 vcc, 2, v20
    s_nop 1
    v_cndmask_b32 v15, v16, v24, vcc
    v_cndmask_b32 v19, v16, v25, vcc
    v_cmp_eq_u32 vcc, 3, v20
    s_nop 1
    v_cndmask_b32 v20, v16, v25, vcc
    v_cndmask_b32 v16, v16, v24, vcc
    v_bfe_u32 v24, v1, 3, 1
    v_lshrrev_b32 v25, 5, v1
    v_cmp_eq_u32 s[54:55], v24, v25
    v_mov_b32 v21, 0xff800000
    v_mov_b32 v22, 0xff800000
    v_mov_b32 v23, 0
    v_mov_b32 v28, 0
    v_mov_b32 v29, 0
    v_mov_b32 v30, 0
    v_mov_b32 v31, 0
    s_mov_b32 s52, 0x3fb8aa3b
    s_mov_b32 s53, 0x3db504f3
    s_barrier
    v_bfe_u32 v25, v1, 3, 1
    v_lshlrev_b32 v25, 8, v25
    v_lshl_add_u32 v25, v2, 4, v25
    v_add_u32 v25, 102400, v25
    ds_read_b128 v[32:35], v25 offset:0
    ds_read_b128 v[36:39], v25 offset:64
    ds_read_b128 v[40:43], v25 offset:128
    ds_read_b128 v[44:47], v25 offset:192
    s_waitcnt lgkmcnt(0)
    s_mov_b32 s51, 0
L_sloop:
    s_cmp_ge_u32 s51, 64
    s_cbranch_scc1 L_send
    s_add_u32 s51, s51, 1
    s_waitcnt vmcnt(5)
    s_add_u32 m0, s50, 20480
    s_nop 0
    buffer_load_dwordx4 v4, s[40:43], s48 offen offset:0 nt lds
    ds_read_b128 v[48:51], v9 offset:0
    ds_read_b128 v[52:55], v10 offset:0
    ds_read_b128 v[56:59], v11 offset:0
    ds_read_b128 v[60:63], v12 offset:0
    s_waitcnt vmcnt(5)
    buffer_load_dwordx4 v5, s[40:43], s48 offen offset:1024 nt lds
    s_waitcnt lgkmcnt(3)
    v_mfma_f32_16x16x32_bf16 v[64:67], v[48:51], v[32:35], 0
    s_waitcnt lgkmcnt(2)
    v_mfma_f32_16x16x32_bf16 v[64:67], v[52:55], v[36:39], v[64:67]
    s_waitcnt lgkmcnt(1)
    v_mfma_f32_16x16x32_bf16 v[64:67], v[56:59], v[40:43], v[64:67]
    s_waitcnt lgkmcnt(0)
    v_mfma_f32_16x16x32_bf16 v[64:67], v[60:63], v[44:47], v[64:67]
    s_waitcnt vmcnt(5)
    buffer_load_dwordx4 v6, s[40:43], s48 offen offset:2048 nt lds
    s_nop 7
    v_cvt_pk_bf16_f32 v68, v64, v65
    v_cvt_pk_bf16_f32 v69, v66, v67
    v_lshlrev_b32 v64, 16, v68
    v_and_b32 v65, 0xffff0000, v68
    v_lshlrev_b32 v66, 16, v69
    v_and_b32 v67, 0xffff0000, v69
    v_mul_f32 v64, s53, v64
    v_mul_f32 v65, s53, v65
    v_mul_f32 v66, s53, v66
    v_mul_f32 v67, s53, v67
    v_cvt_pk_bf16_f32 v68, v64, v65
    v_cvt_pk_bf16_f32 v69, v66, v67
    v_lshlrev_b32 v64, 16, v68
    v_and_b32 v65, 0xffff0000, v68
    v_lshlrev_b32 v66, 16, v69
    v_and_b32 v67, 0xffff0000, v69
    v_max3_f32 v24, v64, v65, v66
    v_max_f32 v24, v24, v67
    v_cmp_gt_f32 vcc, v24, v21
    s_cbranch_vccnz L_rare_0
L_back_0:
    s_waitcnt vmcnt(5)
    buffer_load_dwordx4 v7, s[40:43], s48 offen offset:3072 nt lds
    v_fma_f32 v64, v64, s52, -v22
    v_fma_f32 v65, v65, s52, -v22
    v_fma_f32 v66, v66, s52, -v22
    v_fma_f32 v67, v67, s52, -v22
    v_exp_f32 v64, v64
    v_exp_f32 v65, v65
    v_exp_f32 v66, v66
    v_exp_f32 v67, v67
    s_waitcnt vmcnt(5)
    buffer_load_dwordx4 v[168:171], v8, s[44:47], s48 offen offset:0 nt
    v_cvt_pk_bf16_f32 v68, v64, v65
    v_cvt_pk_bf16_f32 v69, v66, v67
    v_add_f32 v24, v64, v65
    v_add_f32 v25, v66, v67
    v_add_f32 v24, v24, v25
    v_add_f32 v23, v23, v24
    s_waitcnt vmcnt(5)
    buffer_load_dwordx4 v[172:175], v8, s[44:47], s48 offen offset:256 nt
    v_perm_b32 v72, v68, v68, v13
    v_perm_b32 v73, v68, v68, v14
    v_perm_b32 v74, v68, v68, v15
    v_perm_b32 v75, v68, v68, v16
    v_perm_b32 v76, v68, v68, v17
    v_perm_b32 v77, v68, v68, v18
    v_perm_b32 v78, v68, v68, v19
    v_perm_b32 v79, v68, v68, v20
    s_waitcnt vmcnt(5)
    buffer_load_dwordx4 v[176:179], v8, s[44:47], s48 offen offset:512 nt
    v_perm_b32 v80, v69, v69, v13
    v_perm_b32 v81, v69, v69, v14
    v_perm_b32 v82, v69, v69, v15
    v_perm_b32 v83, v69, v69, v16
    v_perm_b32 v84, v69, v69, v17
    v_perm_b32 v85, v69, v69, v18
    v_perm_b32 v86, v69, v69, v19
    v_perm_b32 v87, v69, v69, v20
    s_waitcnt vmcnt(5)
    buffer_load_dwordx4 v[180:183], v8, s[44:47], s48 offen offset:768 nt
    s_add_u32 s48, s48, 16384
    v_mfma_f32_16x16x32_bf16 v[28:31], v[72:75], v[88:91], v[28:31]
    v_mfma_f32_16x16x32_bf16 v[28:31], v[76:79], v[92:95], v[28:31]
    v_mfma_f32_16x16x32_bf16 v[28:31], v[80:83], v[96:99], v[28:31]
    v_mfma_f32_16x16x32_bf16 v[28:31], v[84:87], v[100:103], v[28:31]
    s_cmp_ge_u32 s51, 64
    s_cbranch_scc1 L_send
    s_add_u32 s51, s51, 1
    s_waitcnt vmcnt(5)
    s_add_u32 m0, s50, 0
    s_nop 0
    buffer_load_dwordx4 v4, s[40:43], s48 offen offset:0 nt lds
    ds_read_b128 v[48:51], v9 offset:4096
    ds_read_b128 v[52:55], v10 offset:4096
    ds_read_b128 v[56:59], v11 offset:4096
    ds_read_b128 v[60:63], v12 offset:4096
    s_waitcnt vmcnt(5)
    buffer_load_dwordx4 v5, s[40:43], s48 offen offset:1024 nt lds
    s_waitcnt lgkmcnt(3)
    v_mfma_f32_16x16x32_bf16 v[64:67], v[48:51], v[32:35], 0
    s_waitcnt lgkmcnt(2)
    v_mfma_f32_16x16x32_bf16 v[64:67], v[52:55], v[36:39], v[64:67]
    s_waitcnt lgkmcnt(1)
    v_mfma_f32_16x16x32_bf16 v[64:67], v[56:59], v[40:43], v[64:67]
    s_waitcnt lgkmcnt(0)
    v_mfma_f32_16x16x32_bf16 v[64:67], v[60:63], v[44:47], v[64:67]
    s_waitcnt vmcnt(5)
    buffer_load_dwordx4 v6, s[40:43], s48 offen offset:2048 nt lds
    s_nop 7
    v_cvt_pk_bf16_f32 v68, v64, v65
    v_cvt_pk_bf16_f32 v69, v66, v67
    v_lshlrev_b32 v64, 16, v68
    v_and_b32 v65, 0xffff0000, v68
    v_lshlrev_b32 v66, 16, v69
    v_and_b32 v67, 0xffff0000, v69
    v_mul_f32 v64, s53, v64
    v_mul_f32 v65, s53, v65
    v_mul_f32 v66, s53, v66
    v_mul_f32 v67, s53, v67
    v_cvt_pk_bf16_f32 v68, v64, v65
    v_cvt_pk_bf16_f32 v69, v66, v67
    v_lshlrev_b32 v64, 16, v68
    v_and_b32 v65, 0xffff0000, v68
    v_lshlrev_b32 v66, 16, v69
    v_and_b32 v67, 0xffff0000, v69
    v_max3_f32 v24, v64, v65, v66
    v_max_f32 v24, v24, v67
    v_cmp_gt_f32 vcc, v24, v21
    s_cbranch_vccnz L_rare_1
L_back_1:
    s_waitcnt vmcnt(5)
    buffer_load_dwordx4 v7, s[40:43], s48 offen offset:3072 nt lds
    v_fma_f32 v64, v64, s52, -v22
    v_fma_f32 v65, v65, s52, -v22
    v_fma_f32 v66, v66, s52, -v22
    v_fma_f32 v67, v67, s52, -v22
    v_exp_f32 v64, v64
    v_exp_f32 v65, v65
    v_exp_f32 v66, v66
    v_exp_f32 v67, v67
    s_waitcnt vmcnt(5)
    buffer_load_dwordx4 v[88:91], v8, s[44:47], s48 offen offset:0 nt
    v_cvt_pk_bf16_f32 v68, v64, v65
    v_cvt_pk_bf16_f32 v69, v66, v67
    v_add_f32 v24, v64, v65
    v_add_f32 v25, v66, v67
    v_add_f32 v24, v24, v25
    v_add_f32 v23, v23, v24
    s_waitcnt vmcnt(5)
    buffer_load_dwordx4 v[92:95], v8, s[44:47], s48 offen offset:256 nt
    v_perm_b32 v72, v68, v68, v13
    v_perm_b32 v73, v68, v68, v14
    v_perm_b32 v74, v68, v68, v15
    v_perm_b32 v75, v68, v68, v16
    v_perm_b32 v76, v68, v68, v17
    v_perm_b32 v77, v68, v68, v18
    v_perm_b32 v78, v68, v68, v19
    v_perm_b32 v79, v68, v68, v20
    s_waitcnt vmcnt(5)
    buffer_load_dwordx4 v[96:99], v8, s[44:47], s48 offen offset:512 nt
    v_perm_b32 v80, v69, v69, v13
    v_perm_b32 v81, v69, v69, v14
    v_perm_b32 v82, v69, v69, v15
    v_perm_b32 v83, v69, v69, v16
    v_perm_b32 v84, v69, v69, v17
    v_perm_b32 v85, v69, v69, v18
    v_perm_b32 v86, v69, v69, v19
    v_perm_b32 v87, v69, v69, v20
    s_waitcnt vmcnt(5)
    buffer_load_dwordx4 v[100:103], v8, s[44:47], s48 offen offset:768 nt
    s_add_u32 s48, s48, 16384
    v_mfma_f32_16x16x32_bf16 v[28:31], v[72:75], v[104:107], v[28:31]
    v_mfma_f32_16x16x32_bf16 v[28:31], v[76:79], v[108:111], v[28:31]
    v_mfma_f32_16x16x32_bf16 v[28:31], v[80:83], v[112:115], v[28:31]
    v_mfma_f32_16x16x32_bf16 v[28:31], v[84:87], v[116:119], v[28:31]
    s_cmp_ge_u32 s51, 64
    s_cbranch_scc1 L_send
    s_cmp_eq_u32 s51, 20
    s_cbranch_scc1 L_prog
L_prog_back:
    s_add_u32 s51, s51, 1
    s_waitcnt vmcnt(5)
    s_add_u32 m0, s50, 4096
    s_nop 0
    buffer_load_dwordx4 v4, s[40:43], s48 offen offset:0 nt lds
    ds_read_b128 v[48:51], v9 offset:8192
    ds_read_b128 v[52:55], v10 offset:8192
    ds_read_b128 v[56:59], v11 offset:8192
    ds_read_b128 v[60:63], v12 offset:8192
    s_waitcnt vmcnt(5)
    buffer_load_dwordx4 v5, s[40:43], s48 offen offset:1024 nt lds
    s_waitcnt lgkmcnt(3)
    v_mfma_f32_16x16x32_bf16 v[64:67], v[48:51], v[32:35], 0
    s_waitcnt lgkmcnt(2)
    v_mfma_f32_16x16x32_bf16 v[64:67], v[52:55], v[36:39], v[64:67]
    s_waitcnt lgkmcnt(1)
    v_mfma_f32_16x16x32_bf16 v[64:67], v[56:59], v[40:43], v[64:67]
    s_waitcnt lgkmcnt(0)
    v_mfma_f32_16x16x32_bf16 v[64:67], v[60:63], v[44:47], v[64:67]
    s_waitcnt vmcnt(5)
    buffer_load_dwordx4 v6, s[40:43], s48 offen offset:2048 nt lds
    s_nop 7
    v_cvt_pk_bf16_f32 v68, v64, v65
    v_cvt_pk_bf16_f32 v69, v66, v67
    v_lshlrev_b32 v64, 16, v68
    v_and_b32 v65, 0xffff0000, v68
    v_lshlrev_b32 v66, 16, v69
    v_and_b32 v67, 0xffff0000, v69
    v_mul_f32 v64, s53, v64
    v_mul_f32 v65, s53, v65
    v_mul_f32 v66, s53, v66
    v_mul_f32 v67, s53, v67
    v_cvt_pk_bf16_f32 v68, v64, v65
    v_cvt_pk_bf16_f32 v69, v66, v67
    v_lshlrev_b32 v64, 16, v68
    v_and_b32 v65, 0xffff0000, v68
    v_lshlrev_b32 v66, 16, v69
    v_and_b32 v67, 0xffff0000, v69
    v_max3_f32 v24, v64, v65, v66
    v_max_f32 v24, v24, v67
    v_cmp_gt_f32 vcc, v24, v21
    s_cbranch_vccnz L_rare_2
L_back_2:
    s_waitcnt vmcnt(5)
    buffer_load_dwordx4 v7, s[40:43], s48 offen offset:3072 nt lds
    v_fma_f32 v64, v64, s52, -v22
    v_fma_f32 v65, v65, s52, -v22
    v_fma_f32 v66, v66, s52, -v22
    v_fma_f32 v67, v67, s52, -v22
    v_exp_f32 v64, v64
    v_exp_f32 v65, v65
    v_exp_f32 v66, v66
    v_exp_f32 v67, v67
    s_waitcnt vmcnt(5)
    buffer_load_dwordx4 v[104:107], v8, s[44:47], s48 offen offset:0 nt
    v_cvt_pk_bf16_f32 v68, v64, v65
    v_cvt_pk_bf16_f32 v69, v66, v67
    v_add_f32 v24, v64, v65
    v_add_f32 v25, v66, v67
    v_add_f32 v24, v24, v25
    v_add_f32 v23, v23, v24
    s_waitcnt vmcnt(5)
    buffer_load_dwordx4 v[108:111], v8, s[44:47], s48 offen offset:256 nt
    v_perm_b32 v72, v68, v68, v13
    v_perm_b32 v73, v68, v68, v14
    v_perm_b32 v74, v68, v68, v15
    v_perm_b32 v75, v68, v68, v16
    v_perm_b32 v76, v68, v68, v17
    v_perm_b32 v77, v68, v68, v18
    v_perm_b32 v78, v68, v68, v19
    v_perm_b32 v79, v68, v68, v20
    s_waitcnt vmcnt(5)
    buffer_load_dwordx4 v[112:115], v8, s[44:47], s48 offen offset:512 nt
    v_perm_b32 v80, v69, v69, v13
    v_perm_b32 v81, v69, v69, v14
    v_perm_b32 v82, v69, v69, v15
    v_perm_b32 v83, v69, v69, v16
    v_perm_b32 v84, v69, v69, v17
    v_perm_b32 v85, v69, v69, v18
    v_perm_b32 v86, v69, v69, v19
    v_perm_b32 v87, v69, v69, v20
    s_waitcnt vmcnt(5)
    buffer_load_dwordx4 v[116:119], v8, s[44:47], s48 offen offset:768 nt
    s_add_u32 s48, s48, 16384
    v_mfma_f32_16x16x32_bf16 v[28:31], v[72:75], v[120:123], v[28:31]
    v_mfma_f32_16x16x32_bf16 v[28:31], v[76:79], v[124:127], v[28:31]
    v_mfma_f32_16x16x32_bf16 v[28:31], v[80:83], v[128:131], v[28:31]
    v_mfma_f32_16x16x32_bf16 v[28:31], v[84:87], v[132:135], v[28:31]
    s_cmp_ge_u32 s51, 64
    s_cbranch_scc1 L_send
    s_add_u32 s51, s51, 1
    s_waitcnt vmcnt(5)
    s_add_u32 m0, s50, 8192
    s_nop 0
    buffer_load_dwordx4 v4, s[40:43], s48 offen offset:0 nt lds
    ds_read_b128 v[48:51], v9 offset:12288
    ds_read_b128 v[52:55], v10 offset:12288
    ds_read_b128 v[56:59], v11 offset:12288
    ds_read_b128 v[60:63], v12 offset:12288
    s_waitcnt vmcnt(5)
    buffer_load_dwordx4 v5, s[40:43], s48 offen offset:1024 nt lds
    s_waitcnt lgkmcnt(3)
    v_mfma_f32_16x16x32_bf16 v[64:67], v[48:51], v[32:35], 0
    s_waitcnt lgkmcnt(2)
    v_mfma_f32_16x16x32_bf16 v[64:67], v[52:55], v[36:39], v[64:67]
    s_waitcnt lgkmcnt(1)
    v_mfma_f32_16x16x32_bf16 v[64:67], v[56:59], v[40:43], v[64:67]
    s_waitcnt lgkmcnt(0)
    v_mfma_f32_16x16x32_bf16 v[64:67], v[60:63], v[44:47], v[64:67]
    s_waitcnt vmcnt(5)
    buffer_load_dwordx4 v6, s[40:43], s48 offen offset:2048 nt lds
    s_nop 7
    v_cvt_pk_bf16_f32 v68, v64, v65
    v_cvt_pk_bf16_f32 v69, v66, v67
    v_lshlrev_b32 v64, 16, v68
    v_and_b32 v65, 0xffff0000, v68
    v_lshlrev_b32 v66, 16, v69
    v_and_b32 v67, 0xffff0000, v69
    v_mul_f32 v64, s53, v64
    v_mul_f32 v65, s53, v65
    v_mul_f32 v66, s53, v66
    v_mul_f32 v67, s53, v67
    v_cvt_pk_bf16_f32 v68, v64, v65
    v_cvt_pk_bf16_f32 v69, v66, v67
    v_lshlrev_b32 v64, 16, v68
    v_and_b32 v65, 0xffff0000, v68
    v_lshlrev_b32 v66, 16, v69
    v_and_b32 v67, 0xffff0000, v69
    v_max3_f32 v24, v64, v65, v66
    v_max_f32 v24, v24, v67
    v_cmp_gt_f32 vcc, v24, v21
    s_cbranch_vccnz L_rare_3
L_back_3:
    s_waitcnt vmcnt(5)
    buffer_load_dwordx4 v7, s[40:43], s48 offen offset:3072 nt lds
    v_fma_f32 v64, v64, s52, -v22
    v_fma_f32 v65, v65, s52, -v22
    v_fma_f32 v66, v66, s52, -v22
    v_fma_f32 v67, v67, s52, -v22
    v_exp_f32 v64, v64
    v_exp_f32 v65, v65
    v_exp_f32 v66, v66
    v_exp_f32 v67, v67
    s_waitcnt vmcnt(5)
    buffer_load_dwordx4 v[120:123], v8, s[44:47], s48 offen offset:0 nt
    v_cvt_pk_bf16_f32 v68, v64, v65
    v_cvt_pk_bf16_f32 v69, v66, v67
    v_add_f32 v24, v64, v65
    v_add_f32 v25, v66, v67
    v_add_f32 v24, v24, v25
    v_add_f32 v23, v23, v24
    s_waitcnt vmcnt(5)
    buffer_load_dwordx4 v[124:127], v8, s[44:47], s48 offen offset:256 nt
    v_perm_b32 v72, v68, v68, v13
    v_perm_b32 v73, v68, v68, v14
    v_perm_b32 v74, v68, v68, v15
    v_perm_b32 v75, v68, v68, v16
    v_perm_b32 v76, v68, v68, v17
    v_perm_b32 v77, v68, v68, v18
    v_perm_b32 v78, v68, v68, v19
    v_perm_b32 v79, v68, v68, v20
    s_waitcnt vmcnt(5)
    buffer_load_dwordx4 v[128:131], v8, s[44:47], s48 offen offset:512 nt
    v_perm_b32 v80, v69, v69, v13
    v_perm_b32 v81, v69, v69, v14
    v_perm_b32 v82, v69, v69, v15
    v_perm_b32 v83, v69, v69, v16
    v_perm_b32 v84, v69, v69, v17
    v_perm_b32 v85, v69, v69, v18
    v_perm_b32 v86, v69, v69, v19
    v_perm_b32 v87, v69, v69, v20
    s_waitcnt vmcnt(5)
    buffer_load_dwordx4 v[132:135], v8, s[44:47], s48 offen offset:768 nt
    s_add_u32 s48, s48, 16384
    v_mfma_f32_16x16x32_bf16 v[28:31], v[72:75], v[136:139], v[28:31]
    v_mfma_f32_16x16x32_bf16 v[28:31], v[76:79], v[140:143], v[28:31]
    v_mfma_f32_16x16x32_bf16 v[28:31], v[80:83], v[144:147], v[28:31]
    v_mfma_f32_16x16x32_bf16 v[28:31], v[84:87], v[148:151], v[28:31]
    s_cmp_ge_u32 s51, 64
    s_cbranch_scc1 L_send
    s_add_u32 s51, s51, 1
    s_waitcnt vmcnt(5)
    s_add_u32 m0, s50, 12288
    s_nop 0
    buffer_load_dwordx4 v4, s[40:43], s48 offen offset:0 nt lds
    ds_read_b128 v[48:51], v9 offset:16384
    ds_read_b128 v[52:55], v10 offset:16384
    ds_read_b128 v[56:59], v11 offset:16384
    ds_read_b128 v[60:63], v12 offset:16384
    s_waitcnt vmcnt(5)
    buffer_load_dwordx4 v5, s[40:43], s48 offen offset:1024 nt lds
    s_waitcnt lgkmcnt(3)
    v_mfma_f32_16x16x32_bf16 v[64:67], v[48:51], v[32:35], 0
    s_waitcnt lgkmcnt(2)
    v_mfma_f32_16x16x32_bf16 v[64:67], v[52:55], v[36:39], v[64:67]
    s_waitcnt lgkmcnt(1)
    v_mfma_f32_16x16x32_bf16 v[64:67], v[56:59], v[40:43], v[64:67]
    s_waitcnt lgkmcnt(0)
    v_mfma_f32_16x16x32_bf16 v[64:67], v[60:63], v[44:47], v[64:67]
    s_waitcnt vmcnt(5)
    buffer_load_dwordx4 v6, s[40:43], s48 offen offset:2048 nt lds
    s_nop 7
    v_cvt_pk_bf16_f32 v68, v64, v65
    v_cvt_pk_bf16_f32 v69, v66, v67
    v_lshlrev_b32 v64, 16, v68
    v_and_b32 v65, 0xffff0000, v68
    v_lshlrev_b32 v66, 16, v69
    v_and_b32 v67, 0xffff0000, v69
    v_mul_f32 v64, s53, v64
    v_mul_f32 v65, s53, v65
    v_mul_f32 v66, s53, v66
    v_mul_f32 v67, s53, v67
    v_cvt_pk_bf16_f32 v68, v64, v65
    v_cvt_pk_bf16_f32 v69, v66, v67
    v_lshlrev_b32 v64, 16, v68
    v_and_b32 v65, 0xffff0000, v68
    v_lshlrev_b32 v66, 16, v69
    v_and_b32 v67, 0xffff0000, v69
    v_max3_f32 v24, v64, v65, v66
    v_max_f32 v24, v24, v67
    v_cmp_gt_f32 vcc, v24, v21
    s_cbranch_vccnz L_rare_4
L_back_4:
    s_waitcnt vmcnt(5)
    buffer_load_dwordx4 v7, s[40:43], s48 offen offset:3072 nt lds
    v_fma_f32 v64, v64, s52, -v22
    v_fma_f32 v65, v65, s52, -v22
    v_fma_f32 v66, v66, s52, -v22
    v_fma_f32 v67, v67, s52, -v22
    v_exp_f32 v64, v64
    v_exp_f32 v65, v65
    v_exp_f32 v66, v66
    v_exp_f32 v67, v67
    s_waitcnt vmcnt(5)
    buffer_load_dwordx4 v[136:139], v8, s[44:47], s48 offen offset:0 nt
    v_cvt_pk_bf16_f32 v68, v64, v65
    v_cvt_pk_bf16_f32 v69, v66, v67
    v_add_f32 v24, v64, v65
    v_add_f32 v25, v66, v67
    v_add_f32 v24, v24, v25
    v_add_f32 v23, v23, v24
    s_waitcnt vmcnt(5)
    buffer_load_dwordx4 v[140:143], v8, s[44:47], s48 offen offset:256 nt
    v_perm_b32 v72, v68, v68, v13
    v_perm_b32 v73, v68, v68, v14
    v_perm_b32 v74, v68, v68, v15
    v_perm_b32 v75, v68, v68, v16
    v_perm_b32 v76, v68, v68, v17
    v_perm_b32 v77, v68, v68, v18
    v_perm_b32 v78, v68, v68, v19
    v_perm_b32 v79, v68, v68, v20
    s_waitcnt vmcnt(5)
    buffer_load_dwordx4 v[144:147], v8, s[44:47], s48 offen offset:512 nt
    v_perm_b32 v80, v69, v69, v13
    v_perm_b32 v81, v69, v69, v14
    v_perm_b32 v82, v69, v69, v15
    v_perm_b32 v83, v69, v69, v16
    v_perm_b32 v84, v69, v69, v17
    v_perm_b32 v85, v69, v69, v18
    v_perm_b32 v86, v69, v69, v19
    v_perm_b32 v87, v69, v69, v20
    s_waitcnt vmcnt(5)
    buffer_load_dwordx4 v[148:151], v8, s[44:47], s48 offen offset:768 nt
    s_add_u32 s48, s48, 16384
    v_mfma_f32_16x16x32_bf16 v[28:31], v[72:75], v[152:155], v[28:31]
    v_mfma_f32_16x16x32_bf16 v[28:31], v[76:79], v[156:159], v[28:31]
    v_mfma_f32_16x16x32_bf16 v[28:31], v[80:83], v[160:163], v[28:31]
    v_mfma_f32_16x16x32_bf16 v[28:31], v[84:87], v[164:167], v[28:31]
    s_cmp_ge_u32 s51, 64
    s_cbranch_scc1 L_send
    s_add_u32 s51, s51, 1
    s_waitcnt vmcnt(5)
    s_add_u32 m0, s50, 16384
    s_nop 0
    buffer_load_dwordx4 v4, s[40:43], s48 offen offset:0 nt lds
    ds_read_b128 v[48:51], v9 offset:20480
    ds_read_b128 v[52:55], v10 offset:20480
    ds_read_b128 v[56:59], v11 offset:20480
    ds_read_b128 v[60:63], v12 offset:20480
    s_waitcnt vmcnt(5)
    buffer_load_dwordx4 v5, s[40:43], s48 offen offset:1024 nt lds
    s_waitcnt lgkmcnt(3)
    v_mfma_f32_16x16x32_bf16 v[64:67], v[48:51], v[32:35], 0
    s_waitcnt lgkmcnt(2)
    v_mfma_f32_16x16x32_bf16 v[64:67], v[52:55], v[36:39], v[64:67]
    s_waitcnt lgkmcnt(1)
    v_mfma_f32_16x16x32_bf16 v[64:67], v[56:59], v[40:43], v[64:67]
    s_waitcnt lgkmcnt(0)
    v_mfma_f32_16x16x32_bf16 v[64:67], v[60:63], v[44:47], v[64:67]
    s_waitcnt vmcnt(5)
    buffer_load_dwordx4 v6, s[40:43], s48 offen offset:2048 nt lds
    s_nop 7
    v_cvt_pk_bf16_f32 v68, v64, v65
    v_cvt_pk_bf16_f32 v69, v66, v67
    v_lshlrev_b32 v64, 16, v68
    v_and_b32 v65, 0xffff0000, v68
    v_lshlrev_b32 v66, 16, v69
    v_and_b32 v67, 0xffff0000, v69
    v_mul_f32 v64, s53, v64
    v_mul_f32 v65, s53, v65
    v_mul_f32 v66, s53, v66
    v_mul_f32 v67, s53, v67
    v_cvt_pk_bf16_f32 v68, v64, v65
    v_cvt_pk_bf16_f32 v69, v66, v67
    v_lshlrev_b32 v64, 16, v68
    v_and_b32 v65, 0xffff0000, v68
    v_lshlrev_b32 v66, 16, v69
    v_and_b32 v67, 0xffff0000, v69
    v_max3_f32 v24, v64, v65, v66
    v_max_f32 v24, v24, v67
    v_cmp_gt_f32 vcc, v24, v21
    s_cbranch_vccnz L_rare_5
L_back_5:
    s_waitcnt vmcnt(5)
    buffer_load_dwordx4 v7, s[40:43], s48 offen offset:3072 nt lds
    v_fma_f32 v64, v64, s52, -v22
    v_fma_f32 v65, v65, s52, -v22
    v_fma_f32 v66, v66, s52, -v22
    v_fma_f32 v67, v67, s52, -v22
    v_exp_f32 v64, v64
    v_exp_f32 v65, v65
    v_exp_f32 v66, v66
    v_exp_f32 v67, v67
    s_waitcnt vmcnt(5)
    buffer_load_dwordx4 v[152:155], v8, s[44:47], s48 offen offset:0 nt
    v_cvt_pk_bf16_f32 v68, v64, v65
    v_cvt_pk_bf16_f32 v69, v66, v67
    v_add_f32 v24, v64, v65
    v_add_f32 v25, v66, v67
    v_add_f32 v24, v24, v25
    v_add_f32 v23, v23, v24
    s_waitcnt vmcnt(5)
    buffer_load_dwordx4 v[156:159], v8, s[44:47], s48 offen offset:256 nt
    v_perm_b32 v72, v68, v68, v13
    v_perm_b32 v73, v68, v68, v14
    v_perm_b32 v74, v68, v68, v15
    v_perm_b32 v75, v68, v68, v16
    v_perm_b32 v76, v68, v68, v17
    v_perm_b32 v77, v68, v68, v18
    v_perm_b32 v78, v68, v68, v19
    v_perm_b32 v79, v68, v68, v20
    s_waitcnt vmcnt(5)
    buffer_load_dwordx4 v[160:163], v8, s[44:47], s48 offen offset:512 nt
    v_perm_b32 v80, v69, v69, v13
    v_perm_b32 v81, v69, v69, v14
    v_perm_b32 v82, v69, v69, v15
    v_perm_b32 v83, v69, v69, v16
    v_perm_b32 v84, v69, v69, v17
    v_perm_b32 v85, v69, v69, v18
    v_perm_b32 v86, v69, v69, v19
    v_perm_b32 v87, v69, v69, v20
    s_waitcnt vmcnt(5)
    buffer_load_dwordx4 v[164:167], v8, s[44:47], s48 offen offset:768 nt
    s_add_u32 s48, s48, 16384
    v_mfma_f32_16x16x32_bf16 v[28:31], v[72:75], v[168:171], v[28:31]
    v_mfma_f32_16x16x32_bf16 v[28:31], v[76:79], v[172:175], v[28:31]
    v_mfma_f32_16x16x32_bf16 v[28:31], v[80:83], v[176:179], v[28:31]
    v_mfma_f32_16x16x32_bf16 v[28:31], v[84:87], v[180:183], v[28:31]
    s_branch L_sloop
L_prog:
    s_lshl_b32 s3, s38, 2
    s_add_u32 s3, s3, 121936
    v_mov_b32 v24, s3
    v_mov_b32 v25, 1
    ds_write_b32 v24, v25
    s_branch L_prog_back
L_send:
    v_mov_b32 v24, v23
    s_nop 1
    v_permlane16_swap_b32 v23, v24
    s_nop 1
    v_add_f32 v23, v23, v24
    v_mov_b32 v24, v23
    s_nop 1
    v_permlane32_swap_b32 v23, v24
    s_nop 1
    v_add_f32 v69, v23, v24
    v_mov_b32 v68, v21
    v_lshrrev_b32 v24, 1, v2
    v_lshlrev_b32 v24, 9, v24
    v_lshl_add_u32 v24, v3, 5, v24
    v_and_b32 v25, 1, v2
    v_lshl_add_u32 v24, v25, 4, v24
    s_lshl_b32 s3, s38, 10
    s_add_u32 s3, s3, 104448
    v_add_u32 v24, s3, v24
    s_nop 7
    ds_write_b128 v24, v[28:31]
    v_bfe_u32 v25, v1, 3, 1
    v_lshlrev_b32 v25, 3, v25
    s_lshl_b32 s3, s38, 4
    s_add_u32 s3, s3, 108544
    v_add_u32 v25, s3, v25
    ds_write_b64 v25, v[68:69]
    s_waitcnt lgkmcnt(0)
    s_barrier
    s_endpgm
L_rare_0:
    v_max_f32 v24, v24, v21
    v_mov_b32 v25, v24
    s_nop 1
    v_permlane16_swap_b32 v24, v25
    s_nop 1
    v_max_f32 v24, v24, v25
    v_mov_b32 v25, v24
    s_nop 1
    v_permlane32_swap_b32 v24, v25
    s_nop 1
    v_max_f32 v24, v24, v25
    v_sub_f32 v25, v21, v24
    v_mul_f32 v25, s52, v25
    v_exp_f32 v25, v25
    v_mov_b32 v21, v24
    v_mul_f32 v22, s52, v24
    v_mul_f32 v23, v23, v25
    s_nop 1
    v_mov_b32_dpp v26, v25 row_ror:8 row_mask:0xf bank_mask:0xf
    s_nop 1
    v_cndmask_b32 v26, v26, v25, s[54:55]
    v_mul_f32 v28, v28, v26
    v_mul_f32 v29, v29, v26
    v_mul_f32 v30, v30, v26
    v_mul_f32 v31, v31, v26
    s_nop 1
    s_branch L_back_0
L_rare_1:
    v_max_f32 v24, v24, v21
    v_mov_b32 v25, v24
    s_nop 1
    v_permlane16_swap_b32 v24, v25
    s_nop 1
    v_max_f32 v24, v24, v25
    v_mov_b32 v25, v24
    s_nop 1
    v_permlane32_swap_b32 v24, v25
    s_nop 1
    v_max_f32 v24, v24, v25
    v_sub_f32 v25, v21, v24
    v_mul_f32 v25, s52, v25
    v_exp_f32 v25, v25
    v_mov_b32 v21, v24
    v_mul_f32 v22, s52, v24
    v_mul_f32 v23, v23, v25
    s_nop 1
    v_mov_b32_dpp v26, v25 row_ror:8 row_mask:0xf bank_mask:0xf
    s_nop 1
    v_cndmask_b32 v26, v26, v25, s[54:55]
    v_mul_f32 v28, v28, v26
    v_mul_f32 v29, v29, v26
    v_mul_f32 v30, v30, v26
    v_mul_f32 v31, v31, v26
    s_nop 1
    s_branch L_back_1
L_rare_2:
    v_max_f32 v24, v24, v21
    v_mov_b32 v25, v24
    s_nop 1
    v_permlane16_swap_b32 v24, v25
    s_nop 1
    v_max_f32 v24, v24, v25
    v_mov_b32 v25, v24
    s_nop 1
    v_permlane32_swap_b32 v24, v25
    s_nop 1
    v_max_f32 v24, v24, v25
    v_sub_f32 v25, v21, v24
    v_mul_f32 v25, s52, v25
    v_exp_f32 v25, v25
    v_mov_b32 v21, v24
    v_mul_f32 v22, s52, v24
    v_mul_f32 v23, v23, v25
    s_nop 1
    v_mov_b32_dpp v26, v25 row_ror:8 row_mask:0xf bank_mask:0xf
    s_nop 1
    v_cndmask_b32 v26, v26, v25, s[54:55]
    v_mul_f32 v28, v28, v26
    v_mul_f32 v29, v29, v26
    v_mul_f32 v30, v30, v26
    v_mul_f32 v31, v31, v26
    s_nop 1
    s_branch L_back_2
L_rare_3:
    v_max_f32 v24, v24, v21
    v_mov_b32 v25, v24
    s_nop 1
    v_permlane16_swap_b32 v24, v25
    s_nop 1
    v_max_f32 v24, v24, v25
    v_mov_b32 v25, v24
    s_nop 1
    v_permlane32_swap_b32 v24, v25
    s_nop 1
    v_max_f32 v24, v24, v25
    v_sub_f32 v25, v21, v24
    v_mul_f32 v25, s52, v25
    v_exp_f32 v25, v25
    v_mov_b32 v21, v24
    v_mul_f32 v22, s52, v24
    v_mul_f32 v23, v23, v25
    s_nop 1
    v_mov_b32_dpp v26, v25 row_ror:8 row_mask:0xf bank_mask:0xf
    s_nop 1
    v_cndmask_b32 v26, v26, v25, s[54:55]
    v_mul_f32 v28, v28, v26
    v_mul_f32 v29, v29, v26
    v_mul_f32 v30, v30, v26
    v_mul_f32 v31, v31, v26
    s_nop 1
    s_branch L_back_3
L_rare_4:
    v_max_f32 v24, v24, v21
    v_mov_b32 v25, v24
    s_nop 1
    v_permlane16_swap_b32 v24, v25
    s_nop 1
    v_max_f32 v24, v24, v25
    v_mov_b32 v25, v24
    s_nop 1
    v_permlane32_swap_b32 v24, v25
    s_nop 1
    v_max_f32 v24, v24, v25
    v_sub_f32 v25, v21, v24
    v_mul_f32 v25, s52, v25
    v_exp_f32 v25, v25
    v_mov_b32 v21, v24
    v_mul_f32 v22, s52, v24
    v_mul_f32 v23, v23, v25
    s_nop 1
    v_mov_b32_dpp v26, v25 row_ror:8 row_mask:0xf bank_mask:0xf
    s_nop 1
    v_cndmask_b32 v26, v26, v25, s[54:55]
    v_mul_f32 v28, v28, v26
    v_mul_f32 v29, v29, v26
    v_mul_f32 v30, v30, v26
    v_mul_f32 v31, v31, v26
    s_nop 1
    s_branch L_back_4
L_rare_5:
    v_max_f32 v24, v24, v21
    v_mov_b32 v25, v24
    s_nop 1
    v_permlane16_swap_b32 v24, v25
    s_nop 1
    v_max_f32 v24, v24, v25
    v_mov_b32 v25, v24
    s_nop 1
    v_permlane32_swap_b32 v24, v25
    s_nop 1
    v_max_f32 v24, v24, v25
    v_sub_f32 v25, v21, v24
    v_mul_f32 v25, s52, v25
    v_exp_f32 v25, v25
    v_mov_b32 v21, v24
    v_mul_f32 v22, s52, v24
    v_mul_f32 v23, v23, v25
    s_nop 1
    v_mov_b32_dpp v26, v25 row_ror:8 row_mask:0xf bank_mask:0xf
    s_nop 1
    v_cndmask_b32 v26, v26, v25, s[54:55]
    v_mul_f32 v28, v28, v26
    v_mul_f32 v29, v29, v26
    v_mul_f32 v30, v30, v26
    v_mul_f32 v31, v31, v26
    s_nop 1
    s_branch L_back_5
L_helper:
    s_setprio 3
    v_mov_b32 v12, 121920
    v_mov_b32 v13, 0
    v_lshl_add_u32 v12, v3, 2, v12
    ds_write_b32 v12, v13
    s_memrealtime s[70:71]
    s_waitcnt lgkmcnt(0)
    s_mov_b32 s52, s32
    s_and_b32 s53, s33, 0xffff
    s_mov_b32 s54, 4194304
    s_mov_b32 s55, 0x00020000
    s_cmp_lg_u32 s38, 0
    s_cbranch_scc1 L_hq_other
    s_lshl_b32 s79, s36, 3
    s_add_u32 s79, s79, s37
    s_bfe_u32 s78, s2, 0x40003
    s_and_b32 s6, s2, 7
    s_lshr_b32 s3, s2, 7
    s_lshl_b32 s3, s3, 3
    s_add_u32 s6, s6, s3
    s_mul_i32 s3, s6, 72
    v_bfe_u32 v14, v1, 3, 1
    v_mul_u32_u24 v14, 1152, v14
    v_lshl_add_u32 v14, v2, 1, v14
    v_add_u32 v19, s3, v14
    v_lshlrev_b32 v14, 13, v2
    v_lshl_add_u32 v18, v3, 4, v14
    s_lshl_b32 s4, s78, 9
    s_sub_u32 s5, 4718592, s4
    s_mov_b32 s40, s8
    s_and_b32 s41, s9, 0xffff
    s_mov_b32 s42, 2304
    s_mov_b32 s43, 0x00020000
    s_add_u32 s44, s14, s4
    s_addc_u32 s45, s15, 0
    s_and_b32 s45, s45, 0xffff
    s_mov_b32 s46, s5
    s_mov_b32 s47, 0x00020000
    s_mul_i32 s56, s6, 294912
    buffer_load_dwordx4 v[108:111], v18, s[44:47], s56 offen nt
    buffer_load_dwordx4 v[112:115], v18, s[44:47], s56 offen offset:256 nt
    s_add_u32 s56, s56, 32768
    buffer_load_dwordx4 v[116:119], v18, s[44:47], s56 offen nt
    buffer_load_dwordx4 v[120:123], v18, s[44:47], s56 offen offset:256 nt
    s_add_u32 s56, s56, 32768
    buffer_load_dwordx4 v[124:127], v18, s[44:47], s56 offen nt
    buffer_load_dwordx4 v[128:131], v18, s[44:47], s56 offen offset:256 nt
    s_add_u32 s56, s56, 32768
    buffer_load_dwordx4 v[132:135], v18, s[44:47], s56 offen nt
    buffer_load_dwordx4 v[136:139], v18, s[44:47], s56 offen offset:256 nt
    s_add_u32 s56, s56, 32768
    buffer_load_dwordx4 v[140:143], v18, s[44:47], s56 offen nt
    buffer_load_dwordx4 v[144:147], v18, s[44:47], s56 offen offset:256 nt
    s_add_u32 s56, s56, 32768
    buffer_load_dwordx4 v[148:151], v18, s[44:47], s56 offen nt
    buffer_load_dwordx4 v[152:155], v18, s[44:47], s56 offen offset:256 nt
    s_add_u32 s56, s56, 32768
    buffer_load_dwordx4 v[156:159], v18, s[44:47], s56 offen nt
    buffer_load_dwordx4 v[160:163], v18, s[44:47], s56 offen offset:256 nt
    s_add_u32 s56, s56, 32768
    buffer_load_dwordx4 v[164:167], v18, s[44:47], s56 offen nt
    buffer_load_dwordx4 v[168:171], v18, s[44:47], s56 offen offset:256 nt
    s_add_u32 s56, s56, 32768
    buffer_load_dwordx4 v[172:175], v18, s[44:47], s56 offen nt
    buffer_load_dwordx4 v[176:179], v18, s[44:47], s56 offen offset:256 nt
    s_add_u32 s56, s56, 32768
    buffer_load_ushort v36, v19, s[40:43], 0 offen offset:0
    buffer_load_ushort v37, v19, s[40:43], 0 offen offset:8
    buffer_load_ushort v38, v19, s[40:43], 0 offen offset:16
    buffer_load_ushort v39, v19, s[40:43], 0 offen offset:24
    buffer_load_ushort v40, v19, s[40:43], 0 offen offset:32
    buffer_load_ushort v41, v19, s[40:43], 0 offen offset:40
    buffer_load_ushort v42, v19, s[40:43], 0 offen offset:48
    buffer_load_ushort v43, v19, s[40:43], 0 offen offset:56
    buffer_load_ushort v44, v19, s[40:43], 0 offen offset:64
    s_or_b32 s70, s70, 1
    s_lshl_b32 s7, s78, 3
    s_add_u32 s7, s7, 64
    v_mov_b32 v15, s7
    v_mov_b32 v56, s70
    v_mov_b32 v57, s71
    v_mov_b32 v58, 0
    v_mov_b32 v59, 0
    s_mov_b64 exec, 1
    global_atomic_cmpswap_x2 v[52:53], v15, v[56:59], s[30:31] sc0
    s_mov_b64 exec, -1
    v_and_b32 v12, 1, v1
    v_cmp_eq_u32 vcc, 1, v12
    v_mov_b32 v12, 0x0c0c0100
    v_mov_b32 v13, 0x01000c0c
    s_nop 1
    v_cndmask_b32 v12, v12, v13, vcc
    v_mov_b32 v13, 0x0c0c0302
    v_mov_b32 v8, 0x03020c0c
    v_cndmask_b32 v13, v13, v8, vcc
    v_bfe_u32 v11, v1, 1, 2
    v_mov_b32 v7, 0x0c0c0c0c
    v_cmp_eq_u32 vcc, 0, v11
    s_nop 1
    v_cndmask_b32 v4, v7, v12, vcc
    v_cndmask_b32 v8, v7, v13, vcc
    v_cmp_eq_u32 vcc, 1, v11
    s_nop 1
    v_cndmask_b32 v5, v7, v12, vcc
    v_cndmask_b32 v9, v7, v13, vcc
    v_cmp_eq_u32 vcc, 2, v11
    s_nop 1
    v_cndmask_b32 v6, v7, v12, vcc
    v_cndmask_b32 v10, v7, v13, vcc
    v_cmp_eq_u32 vcc, 3, v11
    s_nop 1
    v_cndmask_b32 v11, v7, v13, vcc
    v_cndmask_b32 v7, v7, v12, vcc
    s_waitcnt vmcnt(1)
    v_perm_b32 v28, v36, v36, v4
    v_perm_b32 v29, v36, v36, v5
    v_perm_b32 v30, v36, v36, v6
    v_perm_b32 v31, v36, v36, v7
    s_nop 1
    v_mfma_f32_16x16x32_bf16 v[20:23], v[28:31], v[108:111], 0
    v_mfma_f32_16x16x32_bf16 v[24:27], v[28:31], v[112:115], 0
    v_perm_b32 v32, v37, v37, v4
    v_perm_b32 v33, v37, v37, v5
    v_perm_b32 v34, v37, v37, v6
    v_perm_b32 v35, v37, v37, v7
    s_nop 1
    v_mfma_f32_16x16x32_bf16 v[20:23], v[32:35], v[116:119], v[20:23]
    v_mfma_f32_16x16x32_bf16 v[24:27], v[32:35], v[120:123], v[24:27]
    v_perm_b32 v28, v38, v38, v4
    v_perm_b32 v29, v38, v38, v5
    v_perm_b32 v30, v38, v38, v6
    v_perm_b32 v31, v38, v38, v7
    s_nop 1
    v_mfma_f32_16x16x32_bf16 v[20:23], v[28:31], v[124:127], v[20:23]
    v_mfma_f32_16x16x32_bf16 v[24:27], v[28:31], v[128:131], v[24:27]
    v_perm_b32 v32, v39, v39, v4
    v_perm_b32 v33, v39, v39, v5
    v_perm_b32 v34, v39, v39, v6
    v_perm_b32 v35, v39, v39, v7
    s_nop 1
    v_mfma_f32_16x16x32_bf16 v[20:23], v[32:35], v[132:135], v[20:23]
    v_mfma_f32_16x16x32_bf16 v[24:27], v[32:35], v[136:139], v[24:27]
    v_perm_b32 v28, v40, v40, v4
    v_perm_b32 v29, v40, v40, v5
    v_perm_b32 v30, v40, v40, v6
    v_perm_b32 v31, v40, v40, v7
    s_nop 1
    v_mfma_f32_16x16x32_bf16 v[20:23], v[28:31], v[140:143], v[20:23]
    v_mfma_f32_16x16x32_bf16 v[24:27], v[28:31], v[144:147], v[24:27]
    v_perm_b32 v32, v41, v41, v4
    v_perm_b32 v33, v41, v41, v5
    v_perm_b32 v34, v41, v41, v6
    v_perm_b32 v35, v41, v41, v7
    s_nop 1
    v_mfma_f32_16x16x32_bf16 v[20:23], v[32:35], v[148:151], v[20:23]
    v_mfma_f32_16x16x32_bf16 v[24:27], v[32:35], v[152:155], v[24:27]
    v_perm_b32 v28, v42, v42, v4
    v_perm_b32 v29, v42, v42, v5
    v_perm_b32 v30, v42, v42, v6
    v_perm_b32 v31, v42, v42, v7
    s_nop 1
    v_mfma_f32_16x16x32_bf16 v[20:23], v[28:31], v[156:159], v[20:23]
    v_mfma_f32_16x16x32_bf16 v[24:27], v[28:31], v[160:163], v[24:27]
    v_perm_b32 v32, v43, v43, v4
    v_perm_b32 v33, v43, v43, v5
    v_perm_b32 v34, v43, v43, v6
    v_perm_b32 v35, v43, v43, v7
    s_nop 1
    v_mfma_f32_16x16x32_bf16 v[20:23], v[32:35], v[164:167], v[20:23]
    v_mfma_f32_16x16x32_bf16 v[24:27], v[32:35], v[168:171], v[24:27]
    v_perm_b32 v28, v44, v44, v4
    v_perm_b32 v29, v44, v44, v5
    v_perm_b32 v30, v44, v44, v6
    v_perm_b32 v31, v44, v44, v7
    s_nop 1
    v_mfma_f32_16x16x32_bf16 v[20:23], v[28:31], v[172:175], v[20:23]
    v_mfma_f32_16x16x32_bf16 v[24:27], v[28:31], v[176:179], v[24:27]
    v_and_b32 v13, 1, v2
    v_lshlrev_b32 v12, 5, v3
    v_lshl_add_u32 v12, v13, 4, v12
    v_lshrrev_b32 v13, 1, v2
    v_lshl_add_u32 v13, v13, 10, v12
    s_lshl_b32 s3, s78, 4
    s_add_u32 s3, s3, s6
    s_lshl_b32 s3, s3, 11
    s_add_u32 s3, s3, 2162688
    s_nop 4
    buffer_store_dwordx4 v[20:23], v13, s[52:55], s3 offen sc1
    buffer_store_dwordx4 v[24:27], v13, s[52:55], s3 offen offset:512 sc1
    s_waitcnt vmcnt(0)
    v_readfirstlane_b32 s4, v52
    v_readfirstlane_b32 s5, v53
    s_or_b32 s3, s4, s5
    s_cmp_eq_u32 s3, 0
    s_cselect_b32 s70, s70, s4
    s_cselect_b32 s71, s71, s5
    v_mov_b32 v52, s70
    v_mov_b32 v53, s71
    s_lshl_b32 s3, s78, 11
    s_add_u32 s3, s3, 2113536
    s_lshl_b32 s4, s6, 3
    v_lshlrev_b32 v14, 7, v1
    v_add_u32 v14, s4, v14
    s_mov_b64 exec, 0xffff
    buffer_store_dwordx2 v[52:53], v14, s[52:55], s3 offen sc1
    s_lshl_b32 s3, s35, 11
    s_add_u32 s3, s3, 2113536
    s_lshl_b32 s4, s79, 7
    s_add_u32 s3, s3, s4
    v_lshlrev_b32 v14, 3, v1
    s_lshl_b32 s4, s35, 3
    s_add_u32 s4, s4, 64
    v_mov_b32 v15, s4
L_qpoll:
    global_load_dwordx2 v[52:53], v15, s[30:31] sc1
    buffer_load_dwordx2 v[28:29], v14, s[52:55], s3 offen sc1
    s_waitcnt vmcnt(0)
    v_or_b32 v16, v52, v53
    v_cmp_ne_u64 vcc, v[28:29], v[52:53]
    v_cmp_eq_u32 s[4:5], 0, v16
    s_nop 1
    s_or_b64 s[4:5], vcc, s[4:5]
    s_cmp_eq_u64 s[4:5], 0
    s_cbranch_scc1 L_qgo
    s_sleep 4
    s_branch L_qpoll
L_qgo:
    s_mov_b64 exec, -1
    s_lshl_b32 s3, s35, 15
    s_lshl_b32 s4, s36, 10
    s_add_u32 s3, s3, s4
    s_add_u32 s3, s3, 2162688
    v_lshlrev_b32 v13, 4, v1
    buffer_load_dwordx4 v[108:111], v13, s[52:55], s3 offen sc1
    s_add_u32 s3, s3, 2048
    buffer_load_dwordx4 v[112:115], v13, s[52:55], s3 offen sc1
    s_add_u32 s3, s3, 2048
    buffer_load_dwordx4 v[116:119], v13, s[52:55], s3 offen sc1
    s_add_u32 s3, s3, 2048
    buffer_load_dwordx4 v[120:123], v13, s[52:55], s3 offen sc1
    s_add_u32 s3, s3, 2048
    buffer_load_dwordx4 v[124:127], v13, s[52:55], s3 offen sc1
    s_add_u32 s3, s3, 2048
    buffer_load_dwordx4 v[128:131], v13, s[52:55], s3 offen sc1
    s_add_u32 s3, s3, 2048
    buffer_load_dwordx4 v[132:135], v13, s[52:55], s3 offen sc1
    s_add_u32 s3, s3, 2048
    buffer_load_dwordx4 v[136:139], v13, s[52:55], s3 offen sc1
    s_add_u32 s3, s3, 2048
    buffer_load_dwordx4 v[140:143], v13, s[52:55], s3 offen sc1
    s_add_u32 s3, s3, 2048
    buffer_load_dwordx4 v[144:147], v13, s[52:55], s3 offen sc1
    s_add_u32 s3, s3, 2048
    buffer_load_dwordx4 v[148:151], v13, s[52:55], s3 offen sc1
    s_add_u32 s3, s3, 2048
    buffer_load_dwordx4 v[152:155], v13, s[52:55], s3 offen sc1
    s_add_u32 s3, s3, 2048
    buffer_load_dwordx4 v[156:159], v13, s[52:55], s3 offen sc1
    s_add_u32 s3, s3, 2048
    buffer_load_dwordx4 v[160:163], v13, s[52:55], s3 offen sc1
    s_add_u32 s3, s3, 2048
    buffer_load_dwordx4 v[164:167], v13, s[52:55], s3 offen sc1
    s_add_u32 s3, s3, 2048
    buffer_load_dwordx4 v[168:171], v13, s[52:55], s3 offen sc1
    s_add_u32 s3, s3, 2048
    s_waitcnt vmcnt(0)
    v_add_f32 v108, v108, v140
    v_add_f32 v109, v109, v141
    v_add_f32 v110, v110, v142
    v_add_f32 v111, v111, v143
    v_add_f32 v112, v112, v144
    v_add_f32 v113, v113, v145
    v_add_f32 v114, v114, v146
    v_add_f32 v115, v115, v147
    v_add_f32 v116, v116, v148
    v_add_f32 v117, v117, v149
    v_add_f32 v118, v118, v150
    v_add_f32 v119, v119, v151
    v_add_f32 v120, v120, v152
    v_add_f32 v121, v121, v153
    v_add_f32 v122, v122, v154
    v_add_f32 v123, v123, v155
    v_add_f32 v124, v124, v156
    v_add_f32 v125, v125, v157
    v_add_f32 v126, v126, v158
    v_add_f32 v127, v127, v159
    v_add_f32 v128, v128, v160
    v_add_f32 v129, v129, v161
    v_add_f32 v130, v130, v162
    v_add_f32 v131, v131, v163
    v_add_f32 v132, v132, v164
    v_add_f32 v133, v133, v165
    v_add_f32 v134, v134, v166
    v_add_f32 v135, v135, v167
    v_add_f32 v136, v136, v168
    v_add_f32 v137, v137, v169
    v_add_f32 v138, v138, v170
    v_add_f32 v139, v139, v171
    v_add_f32 v108, v108, v124
    v_add_f32 v109, v109, v125
    v_add_f32 v110, v110, v126
    v_add_f32 v111, v111, v127
    v_add_f32 v112, v112, v128
    v_add_f32 v113, v113, v129
    v_add_f32 v114, v114, v130
    v_add_f32 v115, v115, v131
    v_add_f32 v116, v116, v132
    v_add_f32 v117, v117, v133
    v_add_f32 v118, v118, v134
    v_add_f32 v119, v119, v135
    v_add_f32 v120, v120, v136
    v_add_f32 v121, v121, v137
    v_add_f32 v122, v122, v138
    v_add_f32 v123, v123, v139
    v_add_f32 v108, v108, v116
    v_add_f32 v109, v109, v117
    v_add_f32 v110, v110, v118
    v_add_f32 v111, v111, v119
    v_add_f32 v112, v112, v120
    v_add_f32 v113, v113, v121
    v_add_f32 v114, v114, v122
    v_add_f32 v115, v115, v123
    v_add_f32 v108, v108, v112
    v_add_f32 v109, v109, v113
    v_add_f32 v110, v110, v114
    v_add_f32 v111, v111, v115
    v_cvt_pk_bf16_f32 v28, v108, v109
    v_cvt_pk_bf16_f32 v29, v110, v111
    v_lshlrev_b32 v13, 3, v1
    v_add_u32 v13, 102400, v13
    ds_write_b64 v13, v[28:29]
    s_branch L_hq_join
L_hq_other:
    v_and_b32 v12, 1, v1
    v_cmp_eq_u32 vcc, 1, v12
    v_mov_b32 v12, 0x0c0c0100
    v_mov_b32 v13, 0x01000c0c
    s_nop 1
    v_cndmask_b32 v12, v12, v13, vcc
    v_mov_b32 v13, 0x0c0c0302
    v_mov_b32 v8, 0x03020c0c
    v_cndmask_b32 v13, v13, v8, vcc
    v_bfe_u32 v11, v1, 1, 2
    v_mov_b32 v7, 0x0c0c0c0c
    v_cmp_eq_u32 vcc, 0, v11
    s_nop 1
    v_cndmask_b32 v4, v7, v12, vcc
    v_cndmask_b32 v8, v7, v13, vcc
    v_cmp_eq_u32 vcc, 1, v11
    s_nop 1
    v_cndmask_b32 v5, v7, v12, vcc
    v_cndmask_b32 v9, v7, v13, vcc
    v_cmp_eq_u32 vcc, 2, v11
    s_nop 1
    v_cndmask_b32 v6, v7, v12, vcc
    v_cndmask_b32 v10, v7, v13, vcc
    v_cmp_eq_u32 vcc, 3, v11
    s_nop 1
    v_cndmask_b32 v11, v7, v13, vcc
    v_cndmask_b32 v7, v7, v12, vcc
    v_and_b32 v13, 1, v2
    v_lshlrev_b32 v12, 5, v3
    v_lshl_add_u32 v12, v13, 4, v12
L_hq_join:
    s_waitcnt lgkmcnt(0)
    s_barrier
    s_mul_i32 s3, s2, 1821
    s_lshr_b32 s63, s3, 16
    s_mul_i32 s3, s63, 36
    s_sub_u32 s64, s2, s3
    s_mul_i32 s3, s63, 96
    s_mul_i32 s4, s38, 24
    s_add_u32 s3, s3, s4
    v_mul_u32_u24 v13, 6, v2
    v_add_u32 v13, s3, v13
    v_mul_u32_u24 v16, 9216, v13
    v_lshl_add_u32 v16, v3, 4, v16
    v_bfe_u32 v14, v1, 3, 1
    v_mul_u32_u24 v14, 1152, v14
    v_lshl_add_u32 v17, v13, 1, v14
    s_lshl_b32 s3, s64, 8
    s_sub_u32 s4, 5308416, s3
    s_cmp_ge_u32 s2, 216
    s_cselect_b32 s4, 0, s4
    s_cselect_b32 s3, 0, s3
    s_cselect_b32 s5, 0, 2304
    s_mov_b32 s40, s8
    s_and_b32 s41, s9, 0xffff
    s_mov_b32 s42, s5
    s_mov_b32 s43, 0x00020000
    s_add_u32 s44, s20, s3
    s_addc_u32 s45, s21, 0
    s_and_b32 s45, s45, 0xffff
    s_mov_b32 s46, s4
    s_mov_b32 s47, 0x00020000
    s_add_u32 s48, s22, s3
    s_addc_u32 s49, s23, 0
    s_and_b32 s49, s49, 0xffff
    s_mov_b32 s50, s4
    s_mov_b32 s51, 0x00020000
    buffer_load_dwordx3 v[48:50], v17, s[40:43], 0 offen
    s_mov_b32 s56, 0
    buffer_load_dwordx4 v[60:63], v16, s[44:47], s56 offen nt
    buffer_load_dwordx4 v[64:67], v16, s[48:51], s56 offen nt
    s_add_u32 s56, s56, 9216
    buffer_load_dwordx4 v[68:71], v16, s[44:47], s56 offen nt
    buffer_load_dwordx4 v[72:75], v16, s[48:51], s56 offen nt
    s_add_u32 s56, s56, 9216
    buffer_load_dwordx4 v[76:79], v16, s[44:47], s56 offen nt
    buffer_load_dwordx4 v[80:83], v16, s[48:51], s56 offen nt
    s_add_u32 s56, s56, 9216
    buffer_load_dwordx4 v[84:87], v16, s[44:47], s56 offen nt
    buffer_load_dwordx4 v[88:91], v16, s[48:51], s56 offen nt
    s_add_u32 s56, s56, 9216
    buffer_load_dwordx4 v[92:95], v16, s[44:47], s56 offen nt
    buffer_load_dwordx4 v[96:99], v16, s[48:51], s56 offen nt
    s_add_u32 s56, s56, 9216
    buffer_load_dwordx4 v[100:103], v16, s[44:47], s56 offen nt
    buffer_load_dwordx4 v[104:107], v16, s[48:51], s56 offen nt
    s_add_u32 s56, s56, 9216
    s_lshl_b32 s3, s38, 6
    v_add_u32 v236, s3, v1
    s_mov_b32 s52, s32
    s_and_b32 s53, s33, 0xffff
    s_mov_b32 s54, 4194304
    s_mov_b32 s55, 0x00020000
    s_lshl_b32 s3, s36, 4
    s_add_u32 s3, s3, s35
    s_lshl_b32 s3, s3, 3
    s_add_u32 s3, s3, s37
    s_lshl_b32 s61, s3, 11
    s_lshl_b32 s3, s36, 3
    s_add_u32 s3, s3, s37
    s_lshl_b32 s3, s3, 4
    s_add_u32 s3, s3, s35
    s_lshl_b32 s3, s3, 10
    s_add_u32 s62, s3, 524288
    v_mov_b32 v13, -1
    v_lshlrev_b32 v14, 2, v236
    buffer_store_dword v13, v14, s[52:55], s61 offen sc1
    buffer_store_dword v13, v14, s[52:55], s62 offen sc1
    v_cmp_gt_u32 vcc, 4, v236
    s_and_saveexec_b64 s[4:5], vcc
    s_cbranch_execz L_i1
    buffer_store_dword v13, v14, s[52:55], s61 offen offset:1024 sc1
L_i1:
    s_mov_b64 exec, s[4:5]
    s_cmp_ge_u32 s2, 216
    s_cbranch_scc1 L_nof1
    s_waitcnt vmcnt(2)
    v_perm_b32 v28, v48, v48, v4
    v_perm_b32 v29, v48, v48, v5
    v_perm_b32 v30, v48, v48, v6
    v_perm_b32 v31, v48, v48, v7
    s_nop 1
    v_mfma_f32_16x16x32_bf16 v[20:23], v[28:31], v[60:63], 0
    v_mfma_f32_16x16x32_bf16 v[24:27], v[28:31], v[64:67], 0
    v_perm_b32 v32, v48, v48, v8
    v_perm_b32 v33, v48, v48, v9
    v_perm_b32 v34, v48, v48, v10
    v_perm_b32 v35, v48, v48, v11
    s_nop 1
    v_mfma_f32_16x16x32_bf16 v[20:23], v[32:35], v[68:71], v[20:23]
    v_mfma_f32_16x16x32_bf16 v[24:27], v[32:35], v[72:75], v[24:27]
    v_perm_b32 v28, v49, v49, v4
    v_perm_b32 v29, v49, v49, v5
    v_perm_b32 v30, v49, v49, v6
    v_perm_b32 v31, v49, v49, v7
    s_nop 1
    v_mfma_f32_16x16x32_bf16 v[20:23], v[28:31], v[76:79], v[20:23]
    v_mfma_f32_16x16x32_bf16 v[24:27], v[28:31], v[80:83], v[24:27]
    v_perm_b32 v32, v49, v49, v8
    v_perm_b32 v33, v49, v49, v9
    v_perm_b32 v34, v49, v49, v10
    v_perm_b32 v35, v49, v49, v11
    s_nop 1
    v_mfma_f32_16x16x32_bf16 v[20:23], v[32:35], v[84:87], v[20:23]
    v_mfma_f32_16x16x32_bf16 v[24:27], v[32:35], v[88:91], v[24:27]
    v_perm_b32 v28, v50, v50, v4
    v_perm_b32 v29, v50, v50, v5
    v_perm_b32 v30, v50, v50, v6
    v_perm_b32 v31, v50, v50, v7
    s_nop 1
    v_mfma_f32_16x16x32_bf16 v[20:23], v[28:31], v[92:95], v[20:23]
    v_mfma_f32_16x16x32_bf16 v[24:27], v[28:31], v[96:99], v[24:27]
    v_perm_b32 v32, v50, v50, v8
    v_perm_b32 v33, v50, v50, v9
    v_perm_b32 v34, v50, v50, v10
    v_perm_b32 v35, v50, v50, v11
    s_nop 1
    v_mfma_f32_16x16x32_bf16 v[20:23], v[32:35], v[100:103], v[20:23]
    v_mfma_f32_16x16x32_bf16 v[24:27], v[32:35], v[104:107], v[24:27]
    v_lshrrev_b32 v13, 1, v2
    v_lshl_add_u32 v13, v13, 9, v12
    s_lshl_b32 s3, s38, 11
    s_add_u32 s3, s3, 108608
    v_add_u32 v13, s3, v13
    s_nop 7
    ds_write_b128 v13, v[20:23]
    ds_write_b128 v13, v[24:27] offset:1024
    s_waitcnt lgkmcnt(0)
    v_mov_b32 v16, 121920
    v_mov_b32 v17, 1
    s_mov_b64 s[4:5], exec
    s_mov_b64 exec, 1
    ds_add_u32 v16, v17
    s_mov_b64 exec, s[4:5]
L_sb_1:
    ds_read_b32 v17, v16
    s_waitcnt lgkmcnt(0)
    v_readfirstlane_b32 s4, v17
    s_cmp_lt_u32 s4, 4
    s_cbranch_scc1 L_sb_1
    v_lshlrev_b32 v13, 3, v236
    v_add_u32 v13, 108608, v13
    ds_read_b64 v[36:37], v13 offset:0
    ds_read_b64 v[38:39], v13 offset:2048
    ds_read_b64 v[40:41], v13 offset:4096
    ds_read_b64 v[42:43], v13 offset:6144
    s_waitcnt lgkmcnt(0)
    v_add_f32 v36, v36, v38
    v_add_f32 v40, v40, v42
    v_add_f32 v37, v37, v39
    v_add_f32 v41, v41, v43
    v_add_f32 v36, v36, v40
    v_add_f32 v37, v37, v41
    s_lshl_b32 s3, s63, 2
    s_add_u32 s3, s3, s38
    s_mul_i32 s3, s3, 18432
    s_lshl_b32 s4, s64, 9
    s_add_u32 s3, s3, s4
    s_add_u32 s3, s3, 786432
    v_lshlrev_b32 v13, 3, v1
    buffer_store_dwordx2 v[36:37], v13, s[52:55], s3 offen sc1
L_nof1:
    s_waitcnt vmcnt(0)
    s_waitcnt lgkmcnt(0)
    v_mov_b32 v16, 121924
    v_mov_b32 v17, 1
    s_mov_b64 s[4:5], exec
    s_mov_b64 exec, 1
    ds_add_u32 v16, v17
    s_mov_b64 exec, s[4:5]
L_sb_2:
    ds_read_b32 v17, v16
    s_waitcnt lgkmcnt(0)
    v_readfirstlane_b32 s4, v17
    s_cmp_lt_u32 s4, 4
    s_cbranch_scc1 L_sb_2
    s_cmp_lg_u32 s38, 0
    s_cbranch_scc1 L_nosig
    v_mov_b32 v13, 0
    v_mov_b32 v14, 1
    s_mov_b64 s[4:5], exec
    s_mov_b64 exec, 1
    global_atomic_add v13, v14, s[30:31]
    s_mov_b64 exec, s[4:5]
L_nosig:
    s_cmp_eq_u32 s37, 7
    s_cselect_b32 s6, 16, 8
    v_cmp_gt_u32 vcc, s6, v3
    v_lshlrev_b32 v13, 4, v3
    v_mov_b32 v14, 0x40000000
    s_nop 0
    v_cndmask_b32 v15, v14, v13, vcc
    s_mul_i32 s3, s38, 82944
    v_mul_u32_u24 v13, 20736, v2
    v_add3_u32 v18, v13, v15, s3
    s_mul_i32 s3, s38, 73728
    v_mul_u32_u24 v13, 18432, v2
    v_add3_u32 v19, v13, v15, s3
    s_mul_i32 s3, s35, 331776
    s_lshl_b32 s4, s37, 7
    s_add_u32 s3, s3, s4
    s_sub_u32 s5, 5308416, s3
    s_add_u32 s40, s24, s3
    s_addc_u32 s41, s25, 0
    s_and_b32 s41, s41, 0xffff
    s_mov_b32 s42, s5
    s_mov_b32 s43, 0x00020000
    s_mul_i32 s3, s35, 294912
    s_add_u32 s3, s3, s4
    s_sub_u32 s5, 4718592, s3
    s_add_u32 s44, s16, s3
    s_addc_u32 s45, s17, 0
    s_and_b32 s45, s45, 0xffff
    s_mov_b32 s46, s5
    s_mov_b32 s47, 0x00020000
    s_mov_b32 s56, 0
    buffer_load_dwordx4 v[60:63], v18, s[40:43], s56 offen nt
    buffer_load_dwordx4 v[132:135], v19, s[44:47], s56 offen nt
    s_add_u32 s56, s56, 1152
    buffer_load_dwordx4 v[64:67], v18, s[40:43], s56 offen nt
    buffer_load_dwordx4 v[136:139], v19, s[44:47], s56 offen nt
    s_add_u32 s56, s56, 1152
    buffer_load_dwordx4 v[68:71], v18, s[40:43], s56 offen nt
    buffer_load_dwordx4 v[140:143], v19, s[44:47], s56 offen nt
    s_add_u32 s56, s56, 1152
    buffer_load_dwordx4 v[72:75], v18, s[40:43], s56 offen nt
    buffer_load_dwordx4 v[144:147], v19, s[44:47], s56 offen nt
    s_add_u32 s56, s56, 1152
    buffer_load_dwordx4 v[76:79], v18, s[40:43], s56 offen nt
    buffer_load_dwordx4 v[148:151], v19, s[44:47], s56 offen nt
    s_add_u32 s56, s56, 1152
    buffer_load_dwordx4 v[80:83], v18, s[40:43], s56 offen nt
    buffer_load_dwordx4 v[152:155], v19, s[44:47], s56 offen nt
    s_add_u32 s56, s56, 1152
    buffer_load_dwordx4 v[84:87], v18, s[40:43], s56 offen nt
    buffer_load_dwordx4 v[156:159], v19, s[44:47], s56 offen nt
    s_add_u32 s56, s56, 1152
    buffer_load_dwordx4 v[88:91], v18, s[40:43], s56 offen nt
    buffer_load_dwordx4 v[160:163], v19, s[44:47], s56 offen nt
    s_add_u32 s56, s56, 1152
    buffer_load_dwordx4 v[92:95], v18, s[40:43], s56 offen nt
    buffer_load_dwordx4 v[164:167], v19, s[44:47], s56 offen nt
    s_add_u32 s56, s56, 1152
    buffer_load_dwordx4 v[96:99], v18, s[40:43], s56 offen nt
    buffer_load_dwordx4 v[168:171], v19, s[44:47], s56 offen nt
    s_add_u32 s56, s56, 1152
    buffer_load_dwordx4 v[100:103], v18, s[40:43], s56 offen nt
    buffer_load_dwordx4 v[172:175], v19, s[44:47], s56 offen nt
    s_add_u32 s56, s56, 1152
    buffer_load_dwordx4 v[104:107], v18, s[40:43], s56 offen nt
    buffer_load_dwordx4 v[176:179], v19, s[44:47], s56 offen nt
    s_add_u32 s56, s56, 1152
    buffer_load_dwordx4 v[108:111], v18, s[40:43], s56 offen nt
    buffer_load_dwordx4 v[180:183], v19, s[44:47], s56 offen nt
    s_add_u32 s56, s56, 1152
    buffer_load_dwordx4 v[112:115], v18, s[40:43], s56 offen nt
    buffer_load_dwordx4 v[184:187], v19, s[44:47], s56 offen nt
    s_add_u32 s56, s56, 1152
    buffer_load_dwordx4 v[116:119], v18, s[40:43], s56 offen nt
    buffer_load_dwordx4 v[188:191], v19, s[44:47], s56 offen nt
    s_add_u32 s56, s56, 1152
    buffer_load_dwordx4 v[120:123], v18, s[40:43], s56 offen nt
    buffer_load_dwordx4 v[192:195], v19, s[44:47], s56 offen nt
    s_add_u32 s56, s56, 1152
    buffer_load_dwordx4 v[124:127], v18, s[40:43], s56 offen nt
    s_add_u32 s56, s56, 1152
    buffer_load_dwordx4 v[128:131], v18, s[40:43], s56 offen nt
    s_add_u32 s56, s56, 1152
    s_or_b32 s3, s35, s38
    s_cmp_lg_u32 s3, 0
    s_cbranch_scc1 L_nog
    v_cmp_gt_u32 vcc, 36, v1
    v_lshlrev_b32 v13, 4, v1
    v_mov_b32 v14, 0x40000000
    s_nop 0
    v_cndmask_b32 v13, v14, v13, vcc
    s_mul_i32 s3, s36, 1152
    s_add_u32 s48, s8, s3
    s_addc_u32 s49, s9, 0
    s_and_b32 s49, s49, 0xffff
    s_mov_b32 s50, 1152
    s_mov_b32 s51, 0x00020000
    buffer_load_dwordx4 v[196:199], v13, s[48:51], 0 offen
    buffer_load_dwordx4 v[200:203], v13, s[48:51], 0 offen offset:576
    s_mov_b32 s48, s26
    s_and_b32 s49, s27, 0xffff
    s_mov_b32 s50, 1152
    s_mov_b32 s51, 0x00020000
    buffer_load_dwordx4 v[204:207], v13, s[48:51], 0 offen
    buffer_load_dwordx4 v[208:211], v13, s[48:51], 0 offen offset:576
    s_waitcnt vmcnt(0)
    v_mov_b32 v16, 0
    v_lshlrev_b32 v13, 16, v196
    v_lshlrev_b32 v14, 16, v204
    v_and_b32 v15, 0xffff0000, v196
    v_and_b32 v17, 0xffff0000, v204
    v_mul_f32 v13, v13, v14
    v_mul_f32 v15, v15, v17
    v_cvt_pk_bf16_f32 v13, v13, v15
    v_lshlrev_b32 v14, 16, v13
    v_and_b32 v15, 0xffff0000, v13
    v_add_f32 v16, v16, v14
    v_add_f32 v16, v16, v15
    v_lshlrev_b32 v13, 16, v197
    v_lshlrev_b32 v14, 16, v205
    v_and_b32 v15, 0xffff0000, v197
    v_and_b32 v17, 0xffff0000, v205
    v_mul_f32 v13, v13, v14
    v_mul_f32 v15, v15, v17
    v_cvt_pk_bf16_f32 v13, v13, v15
    v_lshlrev_b32 v14, 16, v13
    v_and_b32 v15, 0xffff0000, v13
    v_add_f32 v16, v16, v14
    v_add_f32 v16, v16, v15
    v_lshlrev_b32 v13, 16, v198
    v_lshlrev_b32 v14, 16, v206
    v_and_b32 v15, 0xffff0000, v198
    v_and_b32 v17, 0xffff0000, v206
    v_mul_f32 v13, v13, v14
    v_mul_f32 v15, v15, v17
    v_cvt_pk_bf16_f32 v13, v13, v15
    v_lshlrev_b32 v14, 16, v13
    v_and_b32 v15, 0xffff0000, v13
    v_add_f32 v16, v16, v14
    v_add_f32 v16, v16, v15
    v_lshlrev_b32 v13, 16, v199
    v_lshlrev_b32 v14, 16, v207
    v_and_b32 v15, 0xffff0000, v199
    v_and_b32 v17, 0xffff0000, v207
    v_mul_f32 v13, v13, v14
    v_mul_f32 v15, v15, v17
    v_cvt_pk_bf16_f32 v13, v13, v15
    v_lshlrev_b32 v14, 16, v13
    v_and_b32 v15, 0xffff0000, v13
    v_add_f32 v16, v16, v14
    v_add_f32 v16, v16, v15
    v_lshlrev_b32 v13, 16, v200
    v_lshlrev_b32 v14, 16, v208
    v_and_b32 v15, 0xffff0000, v200
    v_and_b32 v17, 0xffff0000, v208
    v_mul_f32 v13, v13, v14
    v_mul_f32 v15, v15, v17
    v_cvt_pk_bf16_f32 v13, v13, v15
    v_lshlrev_b32 v14, 16, v13
    v_and_b32 v15, 0xffff0000, v13
    v_add_f32 v16, v16, v14
    v_add_f32 v16, v16, v15
    v_lshlrev_b32 v13, 16, v201
    v_lshlrev_b32 v14, 16, v209
    v_and_b32 v15, 0xffff0000, v201
    v_and_b32 v17, 0xffff0000, v209
    v_mul_f32 v13, v13, v14
    v_mul_f32 v15, v15, v17
    v_cvt_pk_bf16_f32 v13, v13, v15
    v_lshlrev_b32 v14, 16, v13
    v_and_b32 v15, 0xffff0000, v13
    v_add_f32 v16, v16, v14
    v_add_f32 v16, v16, v15
    v_lshlrev_b32 v13, 16, v202
    v_lshlrev_b32 v14, 16, v210
    v_and_b32 v15, 0xffff0000, v202
    v_and_b32 v17, 0xffff0000, v210
    v_mul_f32 v13, v13, v14
    v_mul_f32 v15, v15, v17
    v_cvt_pk_bf16_f32 v13, v13, v15
    v_lshlrev_b32 v14, 16, v13
    v_and_b32 v15, 0xffff0000, v13
    v_add_f32 v16, v16, v14
    v_add_f32 v16, v16, v15
    v_lshlrev_b32 v13, 16, v203
    v_lshlrev_b32 v14, 16, v211
    v_and_b32 v15, 0xffff0000, v203
    v_and_b32 v17, 0xffff0000, v211
    v_mul_f32 v13, v13, v14
    v_mul_f32 v15, v15, v17
    v_cvt_pk_bf16_f32 v13, v13, v15
    v_lshlrev_b32 v14, 16, v13
    v_and_b32 v15, 0xffff0000, v13
    v_add_f32 v16, v16, v14
    v_add_f32 v16, v16, v15
    s_nop 1
    v_mov_b32_dpp v13, v16 row_ror:8 row_mask:0xf bank_mask:0xf
    v_add_f32 v16, v16, v13
    s_nop 1
    v_mov_b32_dpp v13, v16 row_ror:4 row_mask:0xf bank_mask:0xf
    v_add_f32 v16, v16, v13
    s_nop 1
    v_mov_b32_dpp v13, v16 row_ror:2 row_mask:0xf bank_mask:0xf
    v_add_f32 v16, v16, v13
    s_nop 1
    v_mov_b32_dpp v13, v16 row_ror:1 row_mask:0xf bank_mask:0xf
    v_add_f32 v16, v16, v13
    v_mov_b32 v13, v16
    s_nop 1
    v_permlane16_swap_b32 v16, v13
    s_nop 1
    v_add_f32 v16, v16, v13
    v_mov_b32 v13, v16
    s_nop 1
    v_permlane32_swap_b32 v16, v13
    s_nop 1
    v_add_f32 v16, v16, v13
    v_cvt_pk_bf16_f32 v13, v16, v16
    v_lshlrev_b32 v13, 16, v13
    v_mul_f32 v13, 0xbfb8aa3b, v13
    v_exp_f32 v13, v13
    s_nop 0
    v_add_f32 v13, 1.0, v13
    v_rcp_f32 v13, v13
    s_nop 0
    v_cvt_pk_bf16_f32 v13, v13, v13
    v_lshlrev_b32 v13, 16, v13
    v_sub_f32 v14, 1.0, v13
    v_cvt_pk_bf16_f32 v14, v14, v14
    v_lshlrev_b32 v14, 16, v14
    s_nop 0
    v_readfirstlane_b32 s58, v13
    v_readfirstlane_b32 s59, v14
L_nog:
    s_lshl_b32 s6, s38, 2
    s_add_u32 s6, s6, 121936
    v_mov_b32 v15, s6
L_pwait:
    ds_read_b32 v16, v15
    s_waitcnt lgkmcnt(0)
    v_readfirstlane_b32 s3, v16
    s_cmp_eq_u32 s3, 1
    s_cbranch_scc1 L_cwait
    s_sleep 16
    s_branch L_pwait
L_cwait:
    v_mov_b32 v13, 0
    global_load_dword v14, v13, s[30:31] sc1
    s_waitcnt vmcnt(0)
    v_readfirstlane_b32 s3, v14
    s_cmp_ge_u32 s3, 256
    s_cbranch_scc1 L_cdone
    s_sleep 32
    s_branch L_cwait
L_cdone:
    v_mov_b32 v16, 1
    ds_write_b32 v15, v16 offset:16
    v_cmp_gt_u32 vcc, 36, v1
    v_lshlrev_b32 v13, 3, v1
    v_mov_b32 v14, 0x40000000
    s_nop 0
    v_cndmask_b32 v13, v14, v13, vcc
    s_mul_i32 s3, s35, 1152
    s_mul_i32 s4, s38, 288
    s_add_u32 s3, s3, s4
    s_mul_i32 s4, s36, 18432
    s_add_u32 s3, s3, s4
    s_add_u32 s3, s3, 786432
    buffer_load_dwordx2 v[196:197], v13, s[52:55], s3 offen sc1
    s_add_u32 s3, s3, 36864
    buffer_load_dwordx2 v[198:199], v13, s[52:55], s3 offen sc1
    s_add_u32 s3, s3, 36864
    buffer_load_dwordx2 v[200:201], v13, s[52:55], s3 offen sc1
    s_add_u32 s3, s3, 36864
    buffer_load_dwordx2 v[202:203], v13, s[52:55], s3 offen sc1
    s_add_u32 s3, s3, 36864
    buffer_load_dwordx2 v[204:205], v13, s[52:55], s3 offen sc1
    s_add_u32 s3, s3, 36864
    buffer_load_dwordx2 v[206:207], v13, s[52:55], s3 offen sc1
    s_add_u32 s3, s3, 36864
    buffer_load_dwordx2 v[208:209], v13, s[52:55], s3 offen sc1
    s_add_u32 s3, s3, 36864
    buffer_load_dwordx2 v[210:211], v13, s[52:55], s3 offen sc1
    s_add_u32 s3, s3, 36864
    buffer_load_dwordx2 v[212:213], v13, s[52:55], s3 offen sc1
    s_add_u32 s3, s3, 36864
    buffer_load_dwordx2 v[214:215], v13, s[52:55], s3 offen sc1
    s_add_u32 s3, s3, 36864
    buffer_load_dwordx2 v[216:217], v13, s[52:55], s3 offen sc1
    s_add_u32 s3, s3, 36864
    buffer_load_dwordx2 v[218:219], v13, s[52:55], s3 offen sc1
    s_add_u32 s3, s3, 36864
    s_waitcnt vmcnt(0)
    v_add_f32 v196, v196, v200
    v_add_f32 v196, v196, v204
    v_add_f32 v196, v196, v208
    v_add_f32 v196, v196, v212
    v_add_f32 v196, v196, v216
    v_add_f32 v197, v197, v201
    v_add_f32 v197, v197, v205
    v_add_f32 v197, v197, v209
    v_add_f32 v197, v197, v213
    v_add_f32 v197, v197, v217
    v_add_f32 v198, v198, v202
    v_add_f32 v198, v198, v206
    v_add_f32 v198, v198, v210
    v_add_f32 v198, v198, v214
    v_add_f32 v198, v198, v218
    v_add_f32 v199, v199, v203
    v_add_f32 v199, v199, v207
    v_add_f32 v199, v199, v211
    v_add_f32 v199, v199, v215
    v_add_f32 v199, v199, v219
    v_cvt_pk_bf16_f32 v13, v196, v197
    v_cvt_pk_bf16_f32 v14, v198, v199
    v_lshlrev_b32 v196, 16, v13
    v_and_b32 v197, 0xffff0000, v13
    v_lshlrev_b32 v198, 16, v14
    v_and_b32 v199, 0xffff0000, v14
    s_mov_b32 s3, 0x3d372713
    s_mov_b32 s4, 0xc0135761
    v_mul_f32 v13, v196, v196
    v_fma_f32 v13, v13, s3, 1.0
    v_mul_f32 v13, v13, v196
    v_mul_f32 v13, s4, v13
    v_exp_f32 v13, v13
    s_nop 0
    v_add_f32 v13, 1.0, v13
    v_rcp_f32 v13, v13
    s_nop 0
    v_mul_f32 v196, v196, v13
    v_mul_f32 v13, v197, v197
    v_fma_f32 v13, v13, s3, 1.0
    v_mul_f32 v13, v13, v197
    v_mul_f32 v13, s4, v13
    v_exp_f32 v13, v13
    s_nop 0
    v_add_f32 v13, 1.0, v13
    v_rcp_f32 v13, v13
    s_nop 0
    v_mul_f32 v197, v197, v13
    v_cvt_pk_bf16_f32 v13, v196, v197
    v_lshlrev_b32 v196, 16, v13
    v_and_b32 v197, 0xffff0000, v13
    v_mul_f32 v196, v196, v198
    v_mul_f32 v197, v197, v199
    v_cvt_pk_bf16_f32 v13, v196, v197
    s_mul_i32 s3, s38, 144
    s_add_u32 s3, s3, 116800
    v_lshl_add_u32 v14, v1, 2, s3
    v_cmp_gt_u32 vcc, 36, v1
    s_and_saveexec_b64 s[4:5], vcc
    ds_write_b32 v14, v13
    s_mov_b64 exec, s[4:5]
    v_mul_u32_u24 v14, 36, v2
    v_add_u32 v14, s3, v14
    s_waitcnt lgkmcnt(0)
    ds_read_b32 v36, v14 offset:0
    ds_read_b32 v37, v14 offset:4
    ds_read_b32 v38, v14 offset:8
    ds_read_b32 v39, v14 offset:12
    ds_read_b32 v40, v14 offset:16
    ds_read_b32 v41, v14 offset:20
    ds_read_b32 v42, v14 offset:24
    ds_read_b32 v43, v14 offset:28
    ds_read_b32 v44, v14 offset:32
    s_waitcnt lgkmcnt(0)
    v_perm_b32 v28, v36, v36, v4
    v_perm_b32 v29, v36, v36, v5
    v_perm_b32 v30, v36, v36, v6
    v_perm_b32 v31, v36, v36, v7
    s_nop 1
    v_mfma_f32_16x16x32_bf16 v[24:27], v[28:31], v[60:63], 0
    v_perm_b32 v32, v36, v36, v8
    v_perm_b32 v33, v36, v36, v9
    v_perm_b32 v34, v36, v36, v10
    v_perm_b32 v35, v36, v36, v11
    s_nop 1
    v_mfma_f32_16x16x32_bf16 v[24:27], v[32:35], v[64:67], v[24:27]
    v_perm_b32 v28, v37, v37, v4
    v_perm_b32 v29, v37, v37, v5
    v_perm_b32 v30, v37, v37, v6
    v_perm_b32 v31, v37, v37, v7
    s_nop 1
    v_mfma_f32_16x16x32_bf16 v[24:27], v[28:31], v[68:71], v[24:27]
    v_perm_b32 v32, v37, v37, v8
    v_perm_b32 v33, v37, v37, v9
    v_perm_b32 v34, v37, v37, v10
    v_perm_b32 v35, v37, v37, v11
    s_nop 1
    v_mfma_f32_16x16x32_bf16 v[24:27], v[32:35], v[72:75], v[24:27]
    v_perm_b32 v28, v38, v38, v4
    v_perm_b32 v29, v38, v38, v5
    v_perm_b32 v30, v38, v38, v6
    v_perm_b32 v31, v38, v38, v7
    s_nop 1
    v_mfma_f32_16x16x32_bf16 v[24:27], v[28:31], v[76:79], v[24:27]
    v_perm_b32 v32, v38, v38, v8
    v_perm_b32 v33, v38, v38, v9
    v_perm_b32 v34, v38, v38, v10
    v_perm_b32 v35, v38, v38, v11
    s_nop 1
    v_mfma_f32_16x16x32_bf16 v[24:27], v[32:35], v[80:83], v[24:27]
    v_perm_b32 v28, v39, v39, v4
    v_perm_b32 v29, v39, v39, v5
    v_perm_b32 v30, v39, v39, v6
    v_perm_b32 v31, v39, v39, v7
    s_nop 1
    v_mfma_f32_16x16x32_bf16 v[24:27], v[28:31], v[84:87], v[24:27]
    v_perm_b32 v32, v39, v39, v8
    v_perm_b32 v33, v39, v39, v9
    v_perm_b32 v34, v39, v39, v10
    v_perm_b32 v35, v39, v39, v11
    s_nop 1
    v_mfma_f32_16x16x32_bf16 v[24:27], v[32:35], v[88:91], v[24:27]
    v_perm_b32 v28, v40, v40, v4
    v_perm_b32 v29, v40, v40, v5
    v_perm_b32 v30, v40, v40, v6
    v_perm_b32 v31, v40, v40, v7
    s_nop 1
    v_mfma_f32_16x16x32_bf16 v[24:27], v[28:31], v[92:95], v[24:27]
    v_perm_b32 v32, v40, v40, v8
    v_perm_b32 v33, v40, v40, v9
    v_perm_b32 v34, v40, v40, v10
    v_perm_b32 v35, v40, v40, v11
    s_nop 1
    v_mfma_f32_16x16x32_bf16 v[24:27], v[32:35], v[96:99], v[24:27]
    v_perm_b32 v28, v41, v41, v4
    v_perm_b32 v29, v41, v41, v5
    v_perm_b32 v30, v41, v41, v6
    v_perm_b32 v31, v41, v41, v7
    s_nop 1
    v_mfma_f32_16x16x32_bf16 v[24:27], v[28:31], v[100:103], v[24:27]
    v_perm_b32 v32, v41, v41, v8
    v_perm_b32 v33, v41, v41, v9
    v_perm_b32 v34, v41, v41, v10
    v_perm_b32 v35, v41, v41, v11
    s_nop 1
    v_mfma_f32_16x16x32_bf16 v[24:27], v[32:35], v[104:107], v[24:27]
    v_perm_b32 v28, v42, v42, v4
    v_perm_b32 v29, v42, v42, v5
    v_perm_b32 v30, v42, v42, v6
    v_perm_b32 v31, v42, v42, v7
    s_nop 1
    v_mfma_f32_16x16x32_bf16 v[24:27], v[28:31], v[108:111], v[24:27]
    v_perm_b32 v32, v42, v42, v8
    v_perm_b32 v33, v42, v42, v9
    v_perm_b32 v34, v42, v42, v10
    v_perm_b32 v35, v42, v42, v11
    s_nop 1
    v_mfma_f32_16x16x32_bf16 v[24:27], v[32:35], v[112:115], v[24:27]
    v_perm_b32 v28, v43, v43, v4
    v_perm_b32 v29, v43, v43, v5
    v_perm_b32 v30, v43, v43, v6
    v_perm_b32 v31, v43, v43, v7
    s_nop 1
    v_mfma_f32_16x16x32_bf16 v[24:27], v[28:31], v[116:119], v[24:27]
    v_perm_b32 v32, v43, v43, v8
    v_perm_b32 v33, v43, v43, v9
    v_perm_b32 v34, v43, v43, v10
    v_perm_b32 v35, v43, v43, v11
    s_nop 1
    v_mfma_f32_16x16x32_bf16 v[24:27], v[32:35], v[120:123], v[24:27]
    v_perm_b32 v28, v44, v44, v4
    v_perm_b32 v29, v44, v44, v5
    v_perm_b32 v30, v44, v44, v6
    v_perm_b32 v31, v44, v44, v7
    s_nop 1
    v_mfma_f32_16x16x32_bf16 v[24:27], v[28:31], v[124:127], v[24:27]
    v_perm_b32 v32, v44, v44, v8
    v_perm_b32 v33, v44, v44, v9
    v_perm_b32 v34, v44, v44, v10
    v_perm_b32 v35, v44, v44, v11
    s_nop 1
    v_mfma_f32_16x16x32_bf16 v[24:27], v[32:35], v[128:131], v[24:27]
L_claimstart:
    s_barrier
    s_mov_b32 s60, 0x3fb8aa3b
    v_lshlrev_b32 v13, 2, v236
    v_add_u32 v14, 104448, v13
    ds_read_b32 v196, v14 offset:0
    ds_read_b32 v197, v14 offset:1024
    ds_read_b32 v198, v14 offset:2048
    ds_read_b32 v199, v14 offset:3072
    s_lshr_b32 s3, s38, 1
    s_lshl_b32 s4, s3, 3
    s_add_u32 s4, s4, 108544
    v_mov_b32 v14, s4
    ds_read_b64 v[200:201], v14 offset:0
    ds_read_b64 v[202:203], v14 offset:16
    ds_read_b64 v[204:205], v14 offset:32
    ds_read_b64 v[206:207], v14 offset:48
    s_waitcnt lgkmcnt(0)
    v_max_f32 v36, v200, v202
    v_max_f32 v36, v36, v204
    v_max_f32 v36, v36, v206
    v_sub_f32 v200, v200, v36
    v_mul_f32 v200, s60, v200
    v_exp_f32 v200, v200
    v_sub_f32 v202, v202, v36
    v_mul_f32 v202, s60, v202
    v_exp_f32 v202, v202
    v_sub_f32 v204, v204, v36
    v_mul_f32 v204, s60, v204
    v_exp_f32 v204, v204
    v_sub_f32 v206, v206, v36
    v_mul_f32 v206, s60, v206
    v_exp_f32 v206, v206
    s_nop 0
    v_mul_f32 v15, v196, v200
    v_mul_f32 v37, v201, v200
    v_fmac_f32 v15, v197, v202
    v_fmac_f32 v37, v203, v202
    v_fmac_f32 v15, v198, v204
    v_fmac_f32 v37, v205, v204
    v_fmac_f32 v15, v199, v206
    v_fmac_f32 v37, v207, v206
    buffer_store_dword v15, v13, s[52:55], s61 offen sc1
    s_and_b32 s4, s38, 1
    s_cmp_lg_u32 s4, 0
    s_cbranch_scc1 L_noml
    s_lshl_b32 s4, s3, 3
    v_mov_b32 v14, s4
    s_mov_b64 s[4:5], exec
    s_mov_b64 exec, 1
    buffer_store_dwordx2 v[36:37], v14, s[52:55], s61 offen offset:1024 sc1
    s_mov_b64 exec, s[4:5]
L_noml:
    s_andn2_b32 s4, s61, 16383
    s_lshl_b32 s5, s3, 3
    v_mov_b32 v14, s5
L_poll1:
    s_mov_b32 s5, s4
    buffer_load_dword v196, v13, s[52:55], s5 offen sc1
    buffer_load_dwordx2 v[204:205], v14, s[52:55], s5 offen offset:1024 sc1
    s_add_u32 s5, s5, 2048
    buffer_load_dword v197, v13, s[52:55], s5 offen sc1
    buffer_load_dwordx2 v[206:207], v14, s[52:55], s5 offen offset:1024 sc1
    s_add_u32 s5, s5, 2048
    buffer_load_dword v198, v13, s[52:55], s5 offen sc1
    buffer_load_dwordx2 v[208:209], v14, s[52:55], s5 offen offset:1024 sc1
    s_add_u32 s5, s5, 2048
    buffer_load_dword v199, v13, s[52:55], s5 offen sc1
    buffer_load_dwordx2 v[210:211], v14, s[52:55], s5 offen offset:1024 sc1
    s_add_u32 s5, s5, 2048
    buffer_load_dword v200, v13, s[52:55], s5 offen sc1
    buffer_load_dwordx2 v[212:213], v14, s[52:55], s5 offen offset:1024 sc1
    s_add_u32 s5, s5, 2048
    buffer_load_dword v201, v13, s[52:55], s5 offen sc1
    buffer_load_dwordx2 v[214:215], v14, s[52:55], s5 offen offset:1024 sc1
    s_add_u32 s5, s5, 2048
    buffer_load_dword v202, v13, s[52:55], s5 offen sc1
    buffer_load_dwordx2 v[216:217], v14, s[52:55], s5 offen offset:1024 sc1
    s_add_u32 s5, s5, 2048
    buffer_load_dword v203, v13, s[52:55], s5 offen sc1
    buffer_load_dwordx2 v[218:219], v14, s[52:55], s5 offen offset:1024 sc1
    s_add_u32 s5, s5, 2048
    s_waitcnt vmcnt(0)
    v_max3_u32 v15, v196, v197, v198
    v_max3_u32 v15, v15, v199, v200
    v_max3_u32 v15, v15, v201, v202
    v_max3_u32 v15, v15, v203, v204
    v_max3_u32 v15, v15, v205, v206
    v_max3_u32 v15, v15, v207, v208
    v_max3_u32 v15, v15, v209, v210
    v_max3_u32 v15, v15, v211, v212
    v_max3_u32 v15, v15, v213, v214
    v_max3_u32 v15, v15, v215, v216
    v_max3_u32 v15, v15, v217, v218
    v_max_u32 v15, v15, v219
    v_cmp_eq_u32 vcc, -1, v15
    s_cbranch_vccnz L_poll1
    v_max_f32 v36, v204, v206
    v_max_f32 v36, v36, v208
    v_max_f32 v36, v36, v210
    v_max_f32 v36, v36, v212
    v_max_f32 v36, v36, v214
    v_max_f32 v36, v36, v216
    v_max_f32 v36, v36, v218
    v_sub_f32 v204, v204, v36
    v_mul_f32 v204, s60, v204
    v_exp_f32 v204, v204
    v_sub_f32 v206, v206, v36
    v_mul_f32 v206, s60, v206
    v_exp_f32 v206, v206
    v_sub_f32 v208, v208, v36
    v_mul_f32 v208, s60, v208
    v_exp_f32 v208, v208
    v_sub_f32 v210, v210, v36
    v_mul_f32 v210, s60, v210
    v_exp_f32 v210, v210
    v_sub_f32 v212, v212, v36
    v_mul_f32 v212, s60, v212
    v_exp_f32 v212, v212
    v_sub_f32 v214, v214, v36
    v_mul_f32 v214, s60, v214
    v_exp_f32 v214, v214
    v_sub_f32 v216, v216, v36
    v_mul_f32 v216, s60, v216
    v_exp_f32 v216, v216
    v_sub_f32 v218, v218, v36
    v_mul_f32 v218, s60, v218
    v_exp_f32 v218, v218
    s_nop 0
    v_mul_f32 v15, v196, v204
    v_mul_f32 v37, v205, v204
    v_fmac_f32 v15, v197, v206
    v_fmac_f32 v37, v207, v206
    v_fmac_f32 v15, v198, v208
    v_fmac_f32 v37, v209, v208
    v_fmac_f32 v15, v199, v210
    v_fmac_f32 v37, v211, v210
    v_fmac_f32 v15, v200, v212
    v_fmac_f32 v37, v213, v212
    v_fmac_f32 v15, v201, v214
    v_fmac_f32 v37, v215, v214
    v_fmac_f32 v15, v202, v216
    v_fmac_f32 v37, v217, v216
    v_fmac_f32 v15, v203, v218
    v_fmac_f32 v37, v219, v218
    v_rcp_f32 v16, v37
    s_nop 0
    v_mul_f32 v15, v15, v16
    v_cvt_pk_bf16_f32 v15, v15, v15
    s_nop 1
    s_nop 0
    v_mov_b32_dpp v38, v15 row_newbcast:0 row_mask:0xf bank_mask:0xf
    v_perm_b32 v28, v38, v38, v4
    v_perm_b32 v29, v38, v38, v5
    v_perm_b32 v30, v38, v38, v6
    v_perm_b32 v31, v38, v38, v7
    s_nop 1
    v_mfma_f32_16x16x32_bf16 v[20:23], v[28:31], v[132:135], 0
    s_nop 0
    v_mov_b32_dpp v39, v15 row_newbcast:1 row_mask:0xf bank_mask:0xf
    v_perm_b32 v32, v39, v39, v4
    v_perm_b32 v33, v39, v39, v5
    v_perm_b32 v34, v39, v39, v6
    v_perm_b32 v35, v39, v39, v7
    s_nop 1
    v_mfma_f32_16x16x32_bf16 v[20:23], v[32:35], v[136:139], v[20:23]
    s_nop 0
    v_mov_b32_dpp v38, v15 row_newbcast:2 row_mask:0xf bank_mask:0xf
    v_perm_b32 v28, v38, v38, v4
    v_perm_b32 v29, v38, v38, v5
    v_perm_b32 v30, v38, v38, v6
    v_perm_b32 v31, v38, v38, v7
    s_nop 1
    v_mfma_f32_16x16x32_bf16 v[20:23], v[28:31], v[140:143], v[20:23]
    s_nop 0
    v_mov_b32_dpp v39, v15 row_newbcast:3 row_mask:0xf bank_mask:0xf
    v_perm_b32 v32, v39, v39, v4
    v_perm_b32 v33, v39, v39, v5
    v_perm_b32 v34, v39, v39, v6
    v_perm_b32 v35, v39, v39, v7
    s_nop 1
    v_mfma_f32_16x16x32_bf16 v[20:23], v[32:35], v[144:147], v[20:23]
    s_nop 0
    v_mov_b32_dpp v38, v15 row_newbcast:4 row_mask:0xf bank_mask:0xf
    v_perm_b32 v28, v38, v38, v4
    v_perm_b32 v29, v38, v38, v5
    v_perm_b32 v30, v38, v38, v6
    v_perm_b32 v31, v38, v38, v7
    s_nop 1
    v_mfma_f32_16x16x32_bf16 v[20:23], v[28:31], v[148:151], v[20:23]
    s_nop 0
    v_mov_b32_dpp v39, v15 row_newbcast:5 row_mask:0xf bank_mask:0xf
    v_perm_b32 v32, v39, v39, v4
    v_perm_b32 v33, v39, v39, v5
    v_perm_b32 v34, v39, v39, v6
    v_perm_b32 v35, v39, v39, v7
    s_nop 1
    v_mfma_f32_16x16x32_bf16 v[20:23], v[32:35], v[152:155], v[20:23]
    s_nop 0
    v_mov_b32_dpp v38, v15 row_newbcast:6 row_mask:0xf bank_mask:0xf
    v_perm_b32 v28, v38, v38, v4
    v_perm_b32 v29, v38, v38, v5
    v_perm_b32 v30, v38, v38, v6
    v_perm_b32 v31, v38, v38, v7
    s_nop 1
    v_mfma_f32_16x16x32_bf16 v[20:23], v[28:31], v[156:159], v[20:23]
    s_nop 0
    v_mov_b32_dpp v39, v15 row_newbcast:7 row_mask:0xf bank_mask:0xf
    v_perm_b32 v32, v39, v39, v4
    v_perm_b32 v33, v39, v39, v5
    v_perm_b32 v34, v39, v39, v6
    v_perm_b32 v35, v39, v39, v7
    s_nop 1
    v_mfma_f32_16x16x32_bf16 v[20:23], v[32:35], v[160:163], v[20:23]
    s_nop 0
    v_mov_b32_dpp v38, v15 row_newbcast:8 row_mask:0xf bank_mask:0xf
    v_perm_b32 v28, v38, v38, v4
    v_perm_b32 v29, v38, v38, v5
    v_perm_b32 v30, v38, v38, v6
    v_perm_b32 v31, v38, v38, v7
    s_nop 1
    v_mfma_f32_16x16x32_bf16 v[20:23], v[28:31], v[164:167], v[20:23]
    s_nop 0
    v_mov_b32_dpp v39, v15 row_newbcast:9 row_mask:0xf bank_mask:0xf
    v_perm_b32 v32, v39, v39, v4
    v_perm_b32 v33, v39, v39, v5
    v_perm_b32 v34, v39, v39, v6
    v_perm_b32 v35, v39, v39, v7
    s_nop 1
    v_mfma_f32_16x16x32_bf16 v[20:23], v[32:35], v[168:171], v[20:23]
    s_nop 0
    v_mov_b32_dpp v38, v15 row_newbcast:10 row_mask:0xf bank_mask:0xf
    v_perm_b32 v28, v38, v38, v4
    v_perm_b32 v29, v38, v38, v5
    v_perm_b32 v30, v38, v38, v6
    v_perm_b32 v31, v38, v38, v7
    s_nop 1
    v_mfma_f32_16x16x32_bf16 v[20:23], v[28:31], v[172:175], v[20:23]
    s_nop 0
    v_mov_b32_dpp v39, v15 row_newbcast:11 row_mask:0xf bank_mask:0xf
    v_perm_b32 v32, v39, v39, v4
    v_perm_b32 v33, v39, v39, v5
    v_perm_b32 v34, v39, v39, v6
    v_perm_b32 v35, v39, v39, v7
    s_nop 1
    v_mfma_f32_16x16x32_bf16 v[20:23], v[32:35], v[176:179], v[20:23]
    s_nop 0
    v_mov_b32_dpp v38, v15 row_newbcast:12 row_mask:0xf bank_mask:0xf
    v_perm_b32 v28, v38, v38, v4
    v_perm_b32 v29, v38, v38, v5
    v_perm_b32 v30, v38, v38, v6
    v_perm_b32 v31, v38, v38, v7
    s_nop 1
    v_mfma_f32_16x16x32_bf16 v[20:23], v[28:31], v[180:183], v[20:23]
    s_nop 0
    v_mov_b32_dpp v39, v15 row_newbcast:13 row_mask:0xf bank_mask:0xf
    v_perm_b32 v32, v39, v39, v4
    v_perm_b32 v33, v39, v39, v5
    v_perm_b32 v34, v39, v39, v6
    v_perm_b32 v35, v39, v39, v7
    s_nop 1
    v_mfma_f32_16x16x32_bf16 v[20:23], v[32:35], v[184:187], v[20:23]
    s_nop 0
    v_mov_b32_dpp v38, v15 row_newbcast:14 row_mask:0xf bank_mask:0xf
    v_perm_b32 v28, v38, v38, v4
    v_perm_b32 v29, v38, v38, v5
    v_perm_b32 v30, v38, v38, v6
    v_perm_b32 v31, v38, v38, v7
    s_nop 1
    v_mfma_f32_16x16x32_bf16 v[20:23], v[28:31], v[188:191], v[20:23]
    s_nop 0
    v_mov_b32_dpp v39, v15 row_newbcast:15 row_mask:0xf bank_mask:0xf
    v_perm_b32 v32, v39, v39, v4
    v_perm_b32 v33, v39, v39, v5
    v_perm_b32 v34, v39, v39, v6
    v_perm_b32 v35, v39, v39, v7
    s_nop 1
    v_mfma_f32_16x16x32_bf16 v[20:23], v[32:35], v[192:195], v[20:23]
    s_lshl_b32 s3, s38, 10
    s_add_u32 s3, s3, 117824
    v_add_u32 v14, s3, v12
    s_nop 7
    ds_write_b128 v14, v[20:23]
    ds_write_b128 v14, v[24:27] offset:512
    s_waitcnt lgkmcnt(0)
    s_barrier
    v_lshlrev_b32 v13, 2, v236
    v_add_u32 v14, 117824, v13
    ds_read_b32 v196, v14 offset:0
    ds_read_b32 v197, v14 offset:1024
    ds_read_b32 v198, v14 offset:2048
    ds_read_b32 v199, v14 offset:3072
    s_waitcnt lgkmcnt(0)
    v_add_f32 v196, v196, v197
    v_add_f32 v198, v198, v199
    v_add_f32 v196, v196, v198
    buffer_store_dword v196, v13, s[52:55], s62 offen sc1
    s_or_b32 s3, s35, s38
    s_cmp_lg_u32 s3, 0
    s_cbranch_scc1 L_end
    s_cmp_eq_u32 s37, 7
    s_cselect_b32 s6, 64, 32
    v_cmp_gt_u32 vcc, s6, v1
    s_and_saveexec_b64 s[6:7], vcc
    v_lshlrev_b32 v13, 3, v1
L_poll2:
    s_mov_b32 s5, s62
    buffer_load_dwordx2 v[60:61], v13, s[52:55], s5 offen sc1
    buffer_load_dwordx2 v[62:63], v13, s[52:55], s5 offen offset:512 sc1
    s_add_u32 s5, s5, 1024
    buffer_load_dwordx2 v[64:65], v13, s[52:55], s5 offen sc1
    buffer_load_dwordx2 v[66:67], v13, s[52:55], s5 offen offset:512 sc1
    s_add_u32 s5, s5, 1024
    buffer_load_dwordx2 v[68:69], v13, s[52:55], s5 offen sc1
    buffer_load_dwordx2 v[70:71], v13, s[52:55], s5 offen offset:512 sc1
    s_add_u32 s5, s5, 1024
    buffer_load_dwordx2 v[72:73], v13, s[52:55], s5 offen sc1
    buffer_load_dwordx2 v[74:75], v13, s[52:55], s5 offen offset:512 sc1
    s_add_u32 s5, s5, 1024
    buffer_load_dwordx2 v[76:77], v13, s[52:55], s5 offen sc1
    buffer_load_dwordx2 v[78:79], v13, s[52:55], s5 offen offset:512 sc1
    s_add_u32 s5, s5, 1024
    buffer_load_dwordx2 v[80:81], v13, s[52:55], s5 offen sc1
    buffer_load_dwordx2 v[82:83], v13, s[52:55], s5 offen offset:512 sc1
    s_add_u32 s5, s5, 1024
    buffer_load_dwordx2 v[84:85], v13, s[52:55], s5 offen sc1
    buffer_load_dwordx2 v[86:87], v13, s[52:55], s5 offen offset:512 sc1
    s_add_u32 s5, s5, 1024
    buffer_load_dwordx2 v[88:89], v13, s[52:55], s5 offen sc1
    buffer_load_dwordx2 v[90:91], v13, s[52:55], s5 offen offset:512 sc1
    s_add_u32 s5, s5, 1024
    buffer_load_dwordx2 v[92:93], v13, s[52:55], s5 offen sc1
    buffer_load_dwordx2 v[94:95], v13, s[52:55], s5 offen offset:512 sc1
    s_add_u32 s5, s5, 1024
    buffer_load_dwordx2 v[96:97], v13, s[52:55], s5 offen sc1
    buffer_load_dwordx2 v[98:99], v13, s[52:55], s5 offen offset:512 sc1
    s_add_u32 s5, s5, 1024
    buffer_load_dwordx2 v[100:101], v13, s[52:55], s5 offen sc1
    buffer_load_dwordx2 v[102:103], v13, s[52:55], s5 offen offset:512 sc1
    s_add_u32 s5, s5, 1024
    buffer_load_dwordx2 v[104:105], v13, s[52:55], s5 offen sc1
    buffer_load_dwordx2 v[106:107], v13, s[52:55], s5 offen offset:512 sc1
    s_add_u32 s5, s5, 1024
    buffer_load_dwordx2 v[108:109], v13, s[52:55], s5 offen sc1
    buffer_load_dwordx2 v[110:111], v13, s[52:55], s5 offen offset:512 sc1
    s_add_u32 s5, s5, 1024
    buffer_load_dwordx2 v[112:113], v13, s[52:55], s5 offen sc1
    buffer_load_dwordx2 v[114:115], v13, s[52:55], s5 offen offset:512 sc1
    s_add_u32 s5, s5, 1024
    buffer_load_dwordx2 v[116:117], v13, s[52:55], s5 offen sc1
    buffer_load_dwordx2 v[118:119], v13, s[52:55], s5 offen offset:512 sc1
    s_add_u32 s5, s5, 1024
    buffer_load_dwordx2 v[120:121], v13, s[52:55], s5 offen sc1
    buffer_load_dwordx2 v[122:123], v13, s[52:55], s5 offen offset:512 sc1
    s_add_u32 s5, s5, 1024
    s_waitcnt vmcnt(0)
    v_max3_u32 v15, v60, v61, v62
    v_max3_u32 v15, v15, v63, v64
    v_max3_u32 v15, v15, v65, v66
    v_max3_u32 v15, v15, v67, v68
    v_max3_u32 v15, v15, v69, v70
    v_max3_u32 v15, v15, v71, v72
    v_max3_u32 v15, v15, v73, v74
    v_max3_u32 v15, v15, v75, v76
    v_max3_u32 v15, v15, v77, v78
    v_max3_u32 v15, v15, v79, v80
    v_max3_u32 v15, v15, v81, v82
    v_max3_u32 v15, v15, v83, v84
    v_max3_u32 v15, v15, v85, v86
    v_max3_u32 v15, v15, v87, v88
    v_max3_u32 v15, v15, v89, v90
    v_max3_u32 v15, v15, v91, v92
    v_max3_u32 v15, v15, v93, v94
    v_max3_u32 v15, v15, v95, v96
    v_max3_u32 v15, v15, v97, v98
    v_max3_u32 v15, v15, v99, v100
    v_max3_u32 v15, v15, v101, v102
    v_max3_u32 v15, v15, v103, v104
    v_max3_u32 v15, v15, v105, v106
    v_max3_u32 v15, v15, v107, v108
    v_max3_u32 v15, v15, v109, v110
    v_max3_u32 v15, v15, v111, v112
    v_max3_u32 v15, v15, v113, v114
    v_max3_u32 v15, v15, v115, v116
    v_max3_u32 v15, v15, v117, v118
    v_max3_u32 v15, v15, v119, v120
    v_max3_u32 v15, v15, v121, v122
    v_max_u32 v15, v15, v123
    v_cmp_eq_u32 vcc, -1, v15
    s_cbranch_vccnz L_poll2
    v_add_f32 v60, v60, v64
    v_add_f32 v61, v61, v65
    v_add_f32 v62, v62, v66
    v_add_f32 v63, v63, v67
    v_add_f32 v60, v60, v68
    v_add_f32 v61, v61, v69
    v_add_f32 v62, v62, v70
    v_add_f32 v63, v63, v71
    v_add_f32 v60, v60, v72
    v_add_f32 v61, v61, v73
    v_add_f32 v62, v62, v74
    v_add_f32 v63, v63, v75
    v_add_f32 v60, v60, v76
    v_add_f32 v61, v61, v77
    v_add_f32 v62, v62, v78
    v_add_f32 v63, v63, v79
    v_add_f32 v60, v60, v80
    v_add_f32 v61, v61, v81
    v_add_f32 v62, v62, v82
    v_add_f32 v63, v63, v83
    v_add_f32 v60, v60, v84
    v_add_f32 v61, v61, v85
    v_add_f32 v62, v62, v86
    v_add_f32 v63, v63, v87
    v_add_f32 v60, v60, v88
    v_add_f32 v61, v61, v89
    v_add_f32 v62, v62, v90
    v_add_f32 v63, v63, v91
    v_add_f32 v60, v60, v92
    v_add_f32 v61, v61, v93
    v_add_f32 v62, v62, v94
    v_add_f32 v63, v63, v95
    v_add_f32 v60, v60, v96
    v_add_f32 v61, v61, v97
    v_add_f32 v62, v62, v98
    v_add_f32 v63, v63, v99
    v_add_f32 v60, v60, v100
    v_add_f32 v61, v61, v101
    v_add_f32 v62, v62, v102
    v_add_f32 v63, v63, v103
    v_add_f32 v60, v60, v104
    v_add_f32 v61, v61, v105
    v_add_f32 v62, v62, v106
    v_add_f32 v63, v63, v107
    v_add_f32 v60, v60, v108
    v_add_f32 v61, v61, v109
    v_add_f32 v62, v62, v110
    v_add_f32 v63, v63, v111
    v_add_f32 v60, v60, v112
    v_add_f32 v61, v61, v113
    v_add_f32 v62, v62, v114
    v_add_f32 v63, v63, v115
    v_add_f32 v60, v60, v116
    v_add_f32 v61, v61, v117
    v_add_f32 v62, v62, v118
    v_add_f32 v63, v63, v119
    v_add_f32 v60, v60, v120
    v_add_f32 v61, v61, v121
    v_add_f32 v62, v62, v122
    v_add_f32 v63, v63, v123
    v_cvt_pk_bf16_f32 v14, v60, v61
    v_cvt_pk_bf16_f32 v15, v62, v63
    v_lshlrev_b32 v60, 16, v14
    v_and_b32 v61, 0xffff0000, v14
    v_lshlrev_b32 v62, 16, v15
    v_and_b32 v63, 0xffff0000, v15
    v_mul_f32 v60, s58, v60
    v_mul_f32 v61, s58, v61
    v_mul_f32 v62, s59, v62
    v_mul_f32 v63, s59, v63
    v_cvt_pk_bf16_f32 v14, v60, v61
    v_cvt_pk_bf16_f32 v15, v62, v63
    v_lshlrev_b32 v60, 16, v14
    v_and_b32 v61, 0xffff0000, v14
    v_lshlrev_b32 v62, 16, v15
    v_and_b32 v63, 0xffff0000, v15
    v_add_f32 v60, v60, v62
    v_add_f32 v61, v61, v63
    v_cvt_pk_bf16_f32 v14, v60, v61
    s_mul_i32 s3, s36, 1152
    s_lshl_b32 s4, s37, 7
    s_add_u32 s3, s3, s4
    s_mov_b32 s40, s28
    s_and_b32 s41, s29, 0xffff
    s_mov_b32 s42, 2304
    s_mov_b32 s43, 0x00020000
    v_lshlrev_b32 v13, 2, v1
    buffer_store_dword v14, v13, s[40:43], s3 offen
L_end:
    s_endpgm
.section .rodata,"a"
.p2align 6
.amdhsa_kernel gated_mix__gqa_block_cached__geglu_ffn__decode_kernel
  .amdhsa_next_free_vgpr 256
  .amdhsa_next_free_sgpr 80
  .amdhsa_accum_offset 256
  .amdhsa_group_segment_fixed_size 0
  .amdhsa_kernarg_size 104
  .amdhsa_user_sgpr_count 2
  .amdhsa_user_sgpr_kernarg_segment_ptr 1
  .amdhsa_system_sgpr_workgroup_id_x 1
.end_amdhsa_kernel
```
